```python
import torch

def _softmax(x, axis=-1):
    return torch.softmax(x, dim=axis)
def _gelu(x):
    return torch.nn.functional.gelu(x, approximate="tanh")
def _silu(x):
    return torch.nn.functional.silu(x)
def _sigmoid(x):
    return torch.sigmoid(x)
def _layernorm(x, axis=-1, eps=1e-5):
    m = x.mean(dim=axis, keepdim=True)
    v = x.var(dim=axis, keepdim=True, unbiased=False)
    return (x - m) / torch.sqrt(v + eps)
def _scatter_add(tgt, idx, src, axis=0):
    return tgt.clone().index_add_(axis, idx, src)
def _segment_sum(src, seg, n):
    out = torch.zeros((n,) + src.shape[1:], dtype=src.dtype)
    return out.index_add_(0, seg, src)
def _pad(x, pw):
    flat = tuple(v for pair in reversed(pw) for v in pair)
    return torch.nn.functional.pad(x, flat)

kernel_name = 'interleave_layers__ssm_conv_h3__ssm_conv_s4__prompt'

def setup_inputs():

    _w = (lambda a: (lambda t: t.to(torch.bfloat16) if t.is_floating_point() else t)(torch.as_tensor(a)))
    def _A_setup():
        B, S, D = 1, 2048, 512
        ks = 4
        return {
            "q": _w((lambda *s: torch.randn(*s, dtype=torch.bfloat16) * 0.05)(B, S, D)),
            "k": _w((lambda *s: torch.randn(*s, dtype=torch.bfloat16) * 0.4)(B, S, D)),
            "v": _w((lambda *s: torch.randn(*s, dtype=torch.bfloat16) * 0.4)(B, S, D)),
            "shift_k": _w((lambda *s: torch.randn(*s, dtype=torch.bfloat16) * 0.4)(D, ks) * 0.5),
            "ssm_k": _w((lambda *s: torch.randn(*s, dtype=torch.bfloat16) * 0.4)(D, S) * (1.0 / S ** 0.5)),
            "ssm_D": _w((lambda *s: torch.randn(*s, dtype=torch.bfloat16) * 0.4)(D)),
        }
    _A_in = _A_setup()

    def _B_setup():
        B, L, D, N = 1, 2048, 512, 128
        A_re = -(lambda _x: torch.exp(torch.as_tensor(_x)))((lambda *s: torch.randn(*s, dtype=torch.bfloat16) * 6.4)(D, N))
        A_im = torch.pi * (lambda *s: torch.randn(*s, dtype=torch.bfloat16) * 0.05)(D, N)
        B_re = (lambda *s: torch.randn(*s, dtype=torch.bfloat16) * 0.1)(D, N)
        B_im = (lambda *s: torch.randn(*s, dtype=torch.bfloat16) * 0.1)(D, N)
        C_re = (lambda *s: torch.randn(*s, dtype=torch.bfloat16) * 0.1)(D, N)
        C_im = (lambda *s: torch.randn(*s, dtype=torch.bfloat16) * 0.1)(D, N)
        log_dt = (lambda *s: torch.randn(*s, dtype=torch.bfloat16) * 0.05)(D) * 0.5 - 4.0
        Dskip = (lambda *s: torch.randn(*s, dtype=torch.bfloat16) * 0.05)(D)
        return {
            "u": _w((lambda *s: torch.randn(*s, dtype=torch.bfloat16) * 0.05)(B, L, D)),
            "A_re": _w(A_re),
            "A_im": _w(A_im),
            "B_re": _w(B_re),
            "B_im": _w(B_im),
            "C_re": _w(C_re),
            "C_im": _w(C_im),
            "log_dt": _w(log_dt),
            "Dskip": _w(Dskip),
        }
    _B_in = _B_setup()

    return {
        "A_q": _A_in["q"],
        "A_k": _A_in["k"],
        "A_v": _A_in["v"],
        "A_shift_k": _A_in["shift_k"],
        "A_ssm_k": _A_in["ssm_k"],
        "A_ssm_D": _A_in["ssm_D"],
        "B_u": _B_in["u"],
        "B_A_re": _B_in["A_re"],
        "B_A_im": _B_in["A_im"],
        "B_B_re": _B_in["B_re"],
        "B_B_im": _B_in["B_im"],
        "B_C_re": _B_in["C_re"],
        "B_C_im": _B_in["C_im"],
        "B_log_dt": _B_in["log_dt"],
        "B_Dskip": _B_in["Dskip"],
    }

def reference(A_q, A_k, A_v, A_shift_k, A_ssm_k, A_ssm_D, B_u, B_A_re, B_A_im, B_B_re, B_B_im, B_C_re, B_C_im, B_log_dt, B_Dskip):
    def _A_ref(q, k, v, shift_k, ssm_k, ssm_D):
        B, S, D = q.shape
        ks = shift_k.shape[-1]
        k_pad = _pad(k, ((0, 0), (ks - 1, 0), (0, 0)))
        k_shift = torch.zeros_like(k)
        for t in range(ks):
            k_shift = k_shift + k_pad[:, t:t + S, :] * shift_k[:, ks - 1 - t][None, None, :]
        kv = k_shift * v
        L = 2 * S
        kv_pad = _pad(kv, ((0, 0), (0, S), (0, 0)))
        kf_pad = _pad(ssm_k, ((0, 0), (0, S)))
        kv_f = (lambda x, axes=(-2,-1): torch.fft.rfft2(x.float(), dim=axes))(kv_pad[:, None, :, :], axes=(1, 2))
        kf_f = (lambda x, axes=(-2,-1): torch.fft.rfft2(x.float(), dim=axes))(kf_pad[:, None, :], axes=(1, 2))
        kf_f = (lambda x, *d: x.permute(*d))(kf_f, 1, 2, 0)
        y_f = kv_f * kf_f[None, :, :, :]
        y = (lambda x, s, axes=(-2,-1): torch.fft.irfft2(x, s=s, dim=axes).to(torch.bfloat16))(y_f, (1, L), axes=(1, 2))[:, 0, :S, :]
        y = y + kv * ssm_D[None, None, :]
        return q * y

    def _B_ref(u, A_re, A_im, B_re, B_im, C_re, C_im, log_dt, Dskip):
        Bsz, L, D = u.shape
        dt = torch.exp(log_dt)[:, None]
        A = A_re + 1j * A_im
        Bc = B_re + 1j * B_im
        Cc = C_re + 1j * C_im
        logdA = dt * A
        dB = dt * Bc
        l = (lambda x, dt: x.to(dt))(torch.arange(L), A_re.dtype)
        P = torch.exp(logdA[:, :, None] * l[None, None, :])
        K = torch.einsum("dn,dnl,dn->dl", Cc, P, dB).real
        L2 = 2 * L
        Kp = _pad(K, ((0, 0), (0, L)))
        up = (lambda x, *d: x.permute(*d))(u, 0, 2, 1)
        up = _pad(up, ((0, 0), (0, 0), (0, L)))
        Kf = (lambda x, axes=(-2,-1): torch.fft.rfft2(x.float(), dim=axes))(Kp[:, None, :], axes=(-2, -1))
        Uf = (lambda x, axes=(-2,-1): torch.fft.rfft2(x.float(), dim=axes))(up[:, :, None, :], axes=(-2, -1))
        Yf = Uf * Kf[None, :, :, :]
        y = (lambda x, s, axes=(-2,-1): torch.fft.irfft2(x, s=s, dim=axes).to(torch.bfloat16))(Yf, (1, L2), axes=(-2, -1))[:, :, 0, :L]
        y = (lambda x, *d: x.permute(*d))(y, 0, 2, 1) + u * Dskip[None, None, :]
        return y

    x = A_q
    x = x + _A_ref(_layernorm(x, axis=-1), A_k, A_v, A_shift_k, A_ssm_k, A_ssm_D)
    x = x + _B_ref(_layernorm(x, axis=-1), B_A_re, B_A_im, B_B_re, B_B_im, B_C_re, B_C_im, B_log_dt, B_Dskip)
    x = x + _A_ref(_layernorm(x, axis=-1), A_k, A_v, A_shift_k, A_ssm_k, A_ssm_D)
    x = x + _B_ref(_layernorm(x, axis=-1), B_A_re, B_A_im, B_B_re, B_B_im, B_C_re, B_C_im, B_log_dt, B_Dskip)
    return x
```

```asm
; @launch grid=(256,1,1) block=(512,1,1) lds=162624
.amdgcn_target "amdgcn-amd-amdhsa--gfx950"
.text
.globl interleave_layers__ssm_conv_h3__ssm_conv_s4__prompt_kernel
.p2align 8
.type interleave_layers__ssm_conv_h3__ssm_conv_s4__prompt_kernel,@function
interleave_layers__ssm_conv_h3__ssm_conv_s4__prompt_kernel:
    s_cmp_ge_u32 s2, 256
    s_cbranch_scc1 L_exit
    s_load_dwordx16 s[16:31], s[0:1], 0
    s_load_dwordx16 s[32:47], s[0:1], 64
    s_load_dwordx4 s[48:51], s[0:1], 128
    s_getpc_b64 s[56:57]
L_pc:
    s_sub_u32 s56, s56, L_pc-interleave_layers__ssm_conv_h3__ssm_conv_s4__prompt_kernel
    s_subb_u32 s57, s57, 0
    s_lshr_b32 s58, s2, 3
    s_lshl_b32 s58, s58, 9
    v_and_b32 v52, 7, v0
    v_lshl_add_u32 v52, v52, 6, s58
    v_mov_b32 v53, s57
    v_add_co_u32 v52, vcc, s56, v52
    s_nop 1
    v_addc_co_u32 v53, vcc, 0, v53, vcc
    global_load_dword v23, v[52:53], off
    v_lshrrev_b32 v40, 6, v0
    v_and_b32 v1, 63, v0
    s_and_b32 s4, s2, 7
    s_lshl_b32 s4, s4, 5
    s_lshr_b32 s5, s2, 3
    s_add_u32 s4, s4, s5
    v_readfirstlane_b32 s3, v40
    s_mov_b32 s12, 400000
    s_mov_b32 s13, 1
    s_lshl_b32 s6, s2, 3
    s_add_u32 s6, s6, s3
    s_lshl_b32 s6, s6, 10
    v_lshl_add_u32 v41, v1, 4, s6
    v_add_u32 v42, -3072, v41
    v_lshlrev_b32 v44, 4, v0
    v_add_u32 v44, -4096, v44
    s_mul_i32 s7, s2, 10368
    s_mul_i32 s55, s4, 8320
    s_lshr_b32 s5, s2, 5
    s_mov_b32 s10, 0x200000
    s_mov_b32 s11, 0x20000
    s_mov_b32 s66, 0x200000
    s_mov_b32 s67, 0x20000
    s_lshl_b32 s59, s4, 13
    v_lshl_add_u32 v45, v0, 4, s59
    v_add_u32 v46, 4096, v45
    s_lshl_b32 s56, s4, 9
    s_and_b32 s58, s3, 3
    s_lshl_b32 s59, s58, 7
    s_add_u32 s56, s56, s59
    v_lshl_add_u32 v43, v1, 1, s56
    s_lshl_b32 s56, s4, 2
    s_and_b32 s59, s3, 2
    s_add_u32 s59, s59, s56
    v_mov_b32 v48, s59
    v_mov_b32 v16, 0
    v_mov_b32 v17, 0
    v_mov_b32 v18, 0
    v_mov_b32 v19, 0
    v_mov_b32 v20, 0
    v_mov_b32 v21, 0
    v_mov_b32 v22, 0
    s_mov_b32 s58, 50331648
    s_waitcnt lgkmcnt(0)
    s_mov_b32 s8, s18
    s_mov_b32 s9, s19
    s_mov_b32 s64, s24
    s_mov_b32 s65, s25
    s_cmp_ge_u32 s3, 6
    s_cbranch_scc0 L_nb0
    s_and_b32 s59, s3, 1
    s_lshl_b32 s59, s59, 12
    s_add_u32 s59, s59, s55
    s_add_u32 s59, s59, 2654208
    v_lshl_add_u32 v8, v1, 4, s59
    v_mov_b32 v252, -1
    v_mov_b32 v253, -1
    v_mov_b32 v254, -1
    v_mov_b32 v255, -1
    global_store_dwordx4 v8, v[252:255], s[50:51] offset:0 sc1
    global_store_dwordx4 v8, v[252:255], s[50:51] offset:1024 sc1
    global_store_dwordx4 v8, v[252:255], s[50:51] offset:2048 sc1
    global_store_dwordx4 v8, v[252:255], s[50:51] offset:3072 sc1
L_nb0:
    global_load_short_d16_hi v22, v48, s[42:43]
    global_load_short_d16_hi v16, v43, s[30:31]
    global_load_short_d16_hi v17, v43, s[32:33]
    s_cmp_ge_u32 s3, 4
    s_cbranch_scc1 L_ld4
    global_load_short_d16_hi v18, v43, s[34:35]
    global_load_short_d16_hi v19, v43, s[36:37]
    global_load_short_d16_hi v20, v43, s[38:39]
    global_load_short_d16_hi v21, v43, s[40:41]
    buffer_load_dwordx4 v[128:131], v41, s[8:11], 0 offen
    global_load_dwordx4 v[144:147], v41, s[20:21]
    buffer_load_dwordx4 v[164:167], v42, s[8:11], 0 offen
    s_branch L_ld5
L_ld4:
    buffer_load_dwordx4 v[128:131], v41, s[8:11], 0 offen
    global_load_dwordx4 v[144:147], v41, s[20:21]
    global_load_dwordx4 v[164:167], v44, s[22:23]
L_ld5:
    s_mov_b32 s52, s50
    s_mov_b32 s53, s51
    s_mov_b32 s60, s50
    s_mov_b32 s61, s51
    s_load_dword s14, s[26:27], s56
    s_load_dword s15, s[44:45], s56
    s_load_dword s54, s[50:51], s58
    s_and_b32 s56, s2, 31
    s_and_b32 s58, s56, 7
    s_lshl_b32 s58, s58, 2
    s_lshr_b32 s56, s56, 3
    s_add_u32 s56, s56, s58
    s_lshl_b32 s56, s56, 5
    s_lshl_b32 s58, s5, 10
    s_add_u32 s56, s56, s58
    s_mul_i32 s58, s3, 266240
    s_add_u32 s56, s56, s58
    s_add_u32 s56, s56, 2654208
    v_lshrrev_b32 v54, 2, v1
    v_and_b32 v55, 3, v1
    v_lshrrev_b32 v49, 1, v1
    v_and_b32 v50, 1, v1
    v_mul_u32_u24 v2, 8320, v49
    v_lshl_add_u32 v2, v50, 4, v2
    v_add_u32 v2, s56, v2
    v_add_u32 v13, 532480, v2
    s_mul_i32 s56, s3, 128
    s_add_u32 s56, s56, 135936
    v_lshlrev_b32 v61, 12, v50
    v_lshl_add_u32 v61, v49, 2, v61
    v_add_u32 v61, s56, v61
    v_lshl_add_u32 v3, v0, 4, s7
    s_add_u32 s56, s7, 8192
    v_lshl_add_u32 v4, v0, 2, s56
    s_mul_i32 s56, s3, 1024
    s_add_u32 s56, s56, 135936
    v_lshl_add_u32 v5, v1, 4, s56
    s_mul_i32 s56, s3, 1088
    s_add_u32 s56, s56, 144128
    v_lshl_add_u32 v6, v1, 4, s56
    v_bfe_u32 v40, v0, 2, 2
    v_sub_u32 v40, 3, v40
    v_mul_u32_u24 v7, 1088, v40
    v_and_b32 v40, 0x1f0, v0
    v_lshl_add_u32 v7, v40, 1, v7
    v_lshl_add_u32 v7, v55, 3, v7
    v_add_u32 v7, 143872, v7
    v_mov_b32 v14, 1
    v_mov_b32 v15, 135680
    v_lshlrev_b32 v56, 4, v0
    v_add_u32 v56, 60416, v56
    v_lshlrev_b32 v57, 4, v1
    v_add_u32 v57, 71680, v57
    v_and_b32 v40, 15, v1
    v_lshrrev_b32 v48, 4, v1
    v_lshrrev_b32 v49, 1, v1
    v_and_b32 v50, 1, v1
    v_mov_b32 v8, 0
    v_mov_b32 v9, 0
    v_mov_b32 v10, 0
    v_mov_b32 v11, 0
    v_mov_b32 v12, 0
    v_mov_b32 v60, 0
    v_mov_b32 v228, 0
    v_mov_b32 v229, 0
    v_mov_b32 v230, 0
    v_mov_b32 v231, 0
    v_mov_b32 v232, 0
    v_mov_b32 v233, 0
    v_mov_b32 v234, 0
    v_mov_b32 v235, 0
    v_mov_b32 v236, 0
    s_cmp_ge_u32 s3, 4
    s_cbranch_scc1 L_hadr
    v_mov_b32 v58, v56
    s_lshr_b32 s56, s3, 1
    s_and_b32 s58, s3, 1
    s_mul_i32 s59, s56, 4608
    s_lshl_b32 s62, s58, 8
    s_sub_u32 s59, s59, s62
    s_add_u32 s59, s59, 126800
    v_lshlrev_b32 v8, 1, v40
    v_sub_u32 v8, v8, v48
    v_lshl_add_u32 v8, v8, 4, s59
    v_add_u32 v51, v40, v48
    v_and_b32 v51, 15, v51
    v_lshl_add_u32 v51, v48, 4, v51
    s_lshl_b32 s59, s3, 10
    s_add_u32 s59, s59, 60416
    v_lshl_add_u32 v9, v51, 4, s59
    s_mul_i32 s59, s56, 16640
    s_add_u32 s59, s59, s62
    s_add_u32 s59, s59, 93184
    v_add_u32 v49, 1, v40
    v_and_b32 v50, 3, v49
    v_lshrrev_b32 v49, 2, v49
    v_lshl_add_u32 v49, v48, 1, v49
    v_mul_u32_u24 v10, 4160, v50
    v_lshl_add_u32 v10, v49, 3, v10
    v_add_u32 v10, s59, v10
    s_lshl_b32 s59, s3, 2
    s_add_u32 s59, s59, 135808
    v_mov_b32 v11, s59
    v_lshlrev_b32 v112, 4, v0
    v_add_u32 v112, 93184, v112
    v_add_u32 v60, 128, v61
    v_mov_b32 v64, 0
    v_mov_b32 v65, 0
    v_mov_b32 v66, 0
    v_mov_b32 v67, 0
    s_cmp_eq_u32 s3, 0
    s_cbranch_scc0 L_z1
    v_lshrrev_b32 v49, 5, v1
    v_mul_u32_u24 v49, 4608, v49
    v_and_b32 v50, 31, v1
    v_lshl_add_u32 v49, v50, 4, v49
    v_add_u32 v49, 126464, v49
    ds_write_b128 v49, v[64:67]
L_z1:
    s_cmp_eq_u32 s3, 1
    s_cbranch_scc0 L_z2
    v_and_b32 v49, 15, v1
    v_lshl_add_u32 v49, v49, 4, v15
    ds_write_b128 v49, v[64:67]
L_z2:
    s_cmp_eq_u32 s3, 3
    s_cbranch_scc0 L_z3
    v_add_u32 v58, 13312, v58
L_z3:
    s_branch L_adr_done
L_hadr:
    s_lshl_b32 s59, s3, 8
    s_add_u32 s59, s59, 70656
    v_mul_u32_u24 v58, 1056, v55
    v_lshl_add_u32 v58, v54, 4, v58
    v_add_u32 v58, s59, v58
    s_and_b32 s56, s3, 1
    s_cmp_ge_u32 s3, 6
    s_cbranch_scc1 L_h6
    s_mul_i32 s58, s56, 331776
    v_mul_u32_u24 v51, 10368, v49
    v_add_u32 v51, s58, v51
    s_lshl_b32 s59, s4, 5
    v_lshl_add_u32 v8, v50, 4, v51
    v_add_u32 v8, s59, v8
    s_lshl_b32 s59, s4, 3
    s_add_u32 s59, s59, 8192
    v_lshl_add_u32 v60, v50, 2, v51
    v_add_u32 v60, s59, v60
    s_lshl_b32 s59, s56, 9
    s_add_u32 s59, s59, 126976
    v_mul_u32_u24 v9, 4608, v50
    v_lshl_add_u32 v9, v49, 4, v9
    v_add_u32 v9, s59, v9
    s_lshl_b32 s59, s56, 2
    s_add_u32 s59, s59, 135680
    v_mov_b32 v12, s59
    s_branch L_hg
L_h6:
    v_lshrrev_b32 v51, 2, v49
    v_and_b32 v52, 3, v49
    v_lshl_add_u32 v51, v52, 3, v51
    v_lshl_add_u32 v52, v51, 1, v50
    v_and_b32 v53, 3, v52
    v_lshrrev_b32 v52, 2, v52
    v_add_u32 v52, v52, v53
    v_and_b32 v52, 15, v52
    v_lshl_add_u32 v52, v53, 4, v52
    s_lshl_b32 s59, s56, 12
    s_add_u32 s59, s59, 60416
    v_lshl_add_u32 v10, v52, 4, s59
    s_lshl_b32 s59, s56, 10
    s_add_u32 s59, s59, s55
    s_add_u32 s59, s59, 2657280
    v_lshl_add_u32 v8, v1, 4, s59
    s_lshl_b32 s59, s56, 12
    s_add_u32 s59, s59, s7
    v_lshl_add_u32 v9, v1, 4, s59
    v_mov_b32 v252, -1
    v_mov_b32 v253, -1
    v_mov_b32 v254, -1
    v_mov_b32 v255, -1
    s_lshl_b32 s59, s56, 4
    s_add_u32 s59, s59, 135808
    v_mov_b32 v11, s59
    s_lshl_b32 s59, s56, 2
    s_add_u32 s59, s59, 135776
    v_mov_b32 v12, s59
L_hg:
    s_mov_b32 s56, 663552
    v_mov_b32 v228, v8
    v_mov_b32 v232, v60
    v_add_u32 v229, s56, v228
    v_add_u32 v233, s56, v232
    v_add_u32 v230, s56, v229
    v_add_u32 v234, s56, v233
    v_add_u32 v231, s56, v230
    v_add_u32 v235, s56, v234
L_adr_done:
    s_cmp_lt_u32 s3, 4
    s_cbranch_scc1 L_nhg
    v_and_b32 v42, 255, v0
    v_lshlrev_b32 v43, 3, v42
    v_cvt_f32_u32 v64, v43
    v_add_f32 v65, 0x3f800000, v64
    v_add_f32 v66, 0x40000000, v64
    v_add_f32 v67, 0x40400000, v64
    v_add_f32 v68, 0x40800000, v64
    v_add_f32 v69, 0x40a00000, v64
    v_add_f32 v70, 0x40c00000, v64
    v_add_f32 v71, 0x40e00000, v64
    v_add_f32 v72, 0x41000000, v64
    v_add_f32 v73, 0x41100000, v64
    v_add_f32 v74, 0x41200000, v64
    v_add_f32 v75, 0x41300000, v64
    v_cvt_pk_bf16_f32 v76, v64, v65
    v_cvt_pk_bf16_f32 v77, v66, v67
    v_cvt_pk_bf16_f32 v78, v68, v69
    v_cvt_pk_bf16_f32 v79, v70, v71
    v_cvt_pk_bf16_f32 v80, v72, v73
    v_cvt_pk_bf16_f32 v81, v74, v75
    v_lshlrev_b32 v64, 16, v76
    v_and_b32 v65, 0xffff0000, v76
    v_lshlrev_b32 v66, 16, v77
    v_and_b32 v67, 0xffff0000, v77
    v_lshlrev_b32 v68, 16, v78
    v_and_b32 v69, 0xffff0000, v78
    v_lshlrev_b32 v70, 16, v79
    v_and_b32 v71, 0xffff0000, v79
    v_lshlrev_b32 v72, 16, v80
    v_and_b32 v73, 0xffff0000, v80
    v_lshlrev_b32 v74, 16, v81
    v_and_b32 v75, 0xffff0000, v81
    v_cvt_u32_f32 v64, v64
    v_cvt_u32_f32 v65, v65
    v_cvt_u32_f32 v66, v66
    v_cvt_u32_f32 v67, v67
    v_cvt_u32_f32 v68, v68
    v_cvt_u32_f32 v69, v69
    v_cvt_u32_f32 v70, v70
    v_cvt_u32_f32 v71, v71
    v_cvt_u32_f32 v72, v72
    v_cvt_u32_f32 v73, v73
    v_cvt_u32_f32 v74, v74
    v_cvt_u32_f32 v75, v75
    v_lshrrev_b32 v76, 3, v64
    v_lshrrev_b32 v77, 3, v65
    v_lshrrev_b32 v78, 3, v66
    v_lshrrev_b32 v79, 3, v67
    v_lshrrev_b32 v80, 3, v68
    v_lshrrev_b32 v81, 3, v69
    v_lshrrev_b32 v82, 3, v70
    v_lshrrev_b32 v83, 3, v71
    v_lshrrev_b32 v84, 3, v72
    v_lshrrev_b32 v85, 3, v73
    v_lshrrev_b32 v86, 3, v74
    v_lshrrev_b32 v87, 3, v75
    s_mov_b32 s59, 76416
    v_add3_u32 v64, v64, v76, s59
    v_add3_u32 v65, v65, v77, s59
    v_add3_u32 v66, v66, v78, s59
    v_add3_u32 v67, v67, v79, s59
    v_add3_u32 v68, v68, v80, s59
    v_add3_u32 v69, v69, v81, s59
    v_add3_u32 v70, v70, v82, s59
    v_add3_u32 v71, v71, v83, s59
    v_add3_u32 v72, v72, v84, s59
    v_add3_u32 v73, v73, v85, s59
    v_add3_u32 v74, v74, v86, s59
    v_add3_u32 v75, v75, v87, s59
    v_lshlrev_b32 v28, 1, v64
    v_lshlrev_b32 v29, 1, v65
    v_lshlrev_b32 v30, 1, v66
    v_lshlrev_b32 v31, 1, v67
    v_lshlrev_b32 v32, 1, v68
    v_lshlrev_b32 v33, 1, v69
    v_lshlrev_b32 v34, 1, v70
    v_lshlrev_b32 v35, 1, v71
    v_lshlrev_b32 v36, 1, v72
    v_lshlrev_b32 v37, 1, v73
    v_lshlrev_b32 v38, 1, v74
    v_lshlrev_b32 v39, 1, v75
    v_lshlrev_b32 v239, 4, v42
    v_add_u32 v239, 0, v239
    s_cmp_lt_u32 s3, 6
    s_cbranch_scc1 L_nhg
    s_and_b32 s58, s3, 1
    v_and_b32 v40, 15, v1
    v_lshrrev_b32 v41, 4, v1
    s_mul_i32 s62, s58, 30096
    s_add_u32 s63, s62, 21648
    v_mul_u32_u24 v210, 528, v40
    v_lshl_add_u32 v210, v41, 4, v210
    v_add_u32 v208, s62, v210
    v_add_u32 v210, s63, v210
    v_min_u32 v209, 8, v40
    v_mul_u32_u24 v209, 528, v209
    v_lshl_add_u32 v209, v41, 4, v209
    v_add_u32 v209, s62, v209
    v_mov_b32 v240, 0
    v_mov_b32 v241, 0
    v_mov_b32 v242, 0
    v_mov_b32 v243, 0
    v_mov_b32 v244, 0
    v_mov_b32 v245, 0
    v_mov_b32 v246, 0
    v_mov_b32 v247, 0
    v_mov_b32 v248, 0
    v_mov_b32 v249, 0
    v_mov_b32 v250, 0
    v_mov_b32 v251, 0
    s_mul_i32 s62, s58, 4896
    s_add_u32 s62, s62, 152832
    v_lshlrev_b32 v46, 3, v40
    v_lshrrev_b32 v47, 1, v41
    v_and_b32 v48, 1, v41
    v_lshlrev_b32 v49, 7, v47
    v_lshl_add_u32 v49, v48, 2, v49
    v_add_u32 v49, v49, v46
    v_add_u32 v216, 0, v49
    v_add_u32 v217, 1, v49
    v_add_u32 v218, 2, v49
    v_add_u32 v219, 3, v49
    v_lshlrev_b32 v49, 7, v41
    v_add_u32 v49, 256, v49
    v_lshlrev_b32 v50, 8, v41
    v_cmp_gt_u32 vcc, 2, v41
    v_add_u32 v51, 0, v49
    v_add_u32 v52, 0, v50
    v_cndmask_b32 v51, v52, v51, vcc
    v_add_u32 v220, v51, v46
    v_add_u32 v51, 2, v49
    v_add_u32 v52, 4, v50
    v_cndmask_b32 v51, v52, v51, vcc
    v_add_u32 v221, v51, v46
    v_add_u32 v51, 4, v49
    v_add_u32 v52, 128, v50
    v_cndmask_b32 v51, v52, v51, vcc
    v_add_u32 v222, v51, v46
    v_add_u32 v51, 6, v49
    v_add_u32 v52, 132, v50
    v_cndmask_b32 v51, v52, v51, vcc
    v_add_u32 v223, v51, v46
    v_lshlrev_b32 v51, 2, v41
    v_add_u32 v51, 0, v51
    v_min_u32 v51, 8, v51
    v_lshl_add_u32 v51, v51, 7, v46
    v_add_u32 v224, 1024, v51
    v_lshlrev_b32 v51, 2, v41
    v_add_u32 v51, 1, v51
    v_min_u32 v51, 8, v51
    v_lshl_add_u32 v51, v51, 7, v46
    v_add_u32 v225, 1024, v51
    v_lshlrev_b32 v51, 2, v41
    v_add_u32 v51, 2, v51
    v_min_u32 v51, 8, v51
    v_lshl_add_u32 v51, v51, 7, v46
    v_add_u32 v226, 1024, v51
    v_lshlrev_b32 v51, 2, v41
    v_add_u32 v51, 3, v51
    v_min_u32 v51, 8, v51
    v_lshl_add_u32 v51, v51, 7, v46
    v_add_u32 v227, 1024, v51
    v_lshrrev_b32 v51, 3, v216
    v_add_u32 v51, v51, v216
    v_lshl_add_u32 v216, v51, 1, s62
    v_lshrrev_b32 v51, 3, v217
    v_add_u32 v51, v51, v217
    v_lshl_add_u32 v217, v51, 1, s62
    v_lshrrev_b32 v51, 3, v218
    v_add_u32 v51, v51, v218
    v_lshl_add_u32 v218, v51, 1, s62
    v_lshrrev_b32 v51, 3, v219
    v_add_u32 v51, v51, v219
    v_lshl_add_u32 v219, v51, 1, s62
    v_lshrrev_b32 v51, 3, v220
    v_add_u32 v51, v51, v220
    v_lshl_add_u32 v220, v51, 1, s62
    v_lshrrev_b32 v51, 3, v221
    v_add_u32 v51, v51, v221
    v_lshl_add_u32 v221, v51, 1, s62
    v_lshrrev_b32 v51, 3, v222
    v_add_u32 v51, v51, v222
    v_lshl_add_u32 v222, v51, 1, s62
    v_lshrrev_b32 v51, 3, v223
    v_add_u32 v51, v51, v223
    v_lshl_add_u32 v223, v51, 1, s62
    v_lshrrev_b32 v51, 3, v224
    v_add_u32 v51, v51, v224
    v_lshl_add_u32 v224, v51, 1, s62
    v_lshrrev_b32 v51, 3, v225
    v_add_u32 v51, v51, v225
    v_lshl_add_u32 v225, v51, 1, s62
    v_lshrrev_b32 v51, 3, v226
    v_add_u32 v51, v51, v226
    v_lshl_add_u32 v226, v51, 1, s62
    v_lshrrev_b32 v51, 3, v227
    v_add_u32 v51, v51, v227
    v_lshl_add_u32 v227, v51, 1, s62
L_nhg:
    s_waitcnt vmcnt(3)
    s_bfe_u32 s56, s3, 0x10001
    s_mul_i32 s56, s56, 30096
    s_and_b32 s58, s3, 1
    s_lshl_b32 s58, s58, 8
    s_add_u32 s56, s56, s58
    v_lshl_add_u32 v62, v1, 2, s56
    v_mul_f32 v22, 0x3fb8aa3b, v22
    v_exp_f32 v22, v22
    s_nop 0
    v_cvt_pk_bf16_f32 v22, v22, v22
    v_lshlrev_b32 v22, 16, v22
    v_mul_f32 v16, v16, v22
    v_mul_f32 v17, v17, v22
    v_mul_f32 v16, 0x3fb8aa3b, v16
    v_mul_f32 v17, 0x3e22f983, v17
    s_cmp_ge_u32 s3, 4
    s_cbranch_scc1 L_kb
    v_mul_f32 v90, 0x41000000, v16
    v_mul_f32 v65, 0x41000000, v17
    v_mul_f32 v92, 0x43000000, v16
    v_mul_f32 v67, 0x43000000, v17
    v_mul_f32 v94, 0x44800000, v16
    v_mul_f32 v79, 0x44800000, v17
    v_fract_f32 v65, v65
    v_fract_f32 v67, v67
    v_fract_f32 v79, v79
    v_exp_f32 v90, v90
    v_exp_f32 v92, v92
    v_exp_f32 v94, v94
    v_cos_f32 v64, v65
    v_cos_f32 v66, v67
    v_cos_f32 v78, v79
    v_sin_f32 v65, v65
    v_sin_f32 v67, v67
    v_sin_f32 v79, v79
    v_pk_mul_f32 v[64:65], v[64:65], v[90:91] op_sel_hi:[1,0]
    v_pk_mul_f32 v[66:67], v[66:67], v[92:93] op_sel_hi:[1,0]
    v_pk_mul_f32 v[78:79], v[78:79], v[94:95] op_sel_hi:[1,0]
    v_mul_f32 v18, v18, v22
    v_mul_f32 v19, v19, v22
    v_pk_mul_f32 v[70:71], v[20:21], v[18:19] op_sel:[0,0] op_sel_hi:[0,1]
    v_pk_mul_f32 v[68:69], v[64:65], v[64:65] op_sel:[0,0] op_sel_hi:[0,1]
    v_pk_fma_f32 v[70:71], v[20:21], v[18:19], v[70:71] op_sel:[1,1,0] op_sel_hi:[1,0,1] neg_lo:[1,0,0]
    v_pk_fma_f32 v[68:69], v[64:65], v[64:65], v[68:69] op_sel:[1,1,0] op_sel_hi:[1,0,1] neg_lo:[1,0,0]
    v_pk_mul_f32 v[74:75], v[70:71], v[64:65] op_sel:[0,0] op_sel_hi:[0,1]
    v_pk_fma_f32 v[74:75], v[70:71], v[64:65], v[74:75] op_sel:[1,1,0] op_sel_hi:[1,0,1] neg_lo:[1,0,0]
    v_pk_mul_f32 v[80:81], v[78:79], v[66:67] op_sel:[0,0] op_sel_hi:[0,1]
    v_pk_mul_f32 v[72:73], v[70:71], v[68:69] op_sel:[0,0] op_sel_hi:[0,1]
    v_pk_mul_f32 v[76:77], v[74:75], v[68:69] op_sel:[0,0] op_sel_hi:[0,1]
    v_pk_fma_f32 v[80:81], v[78:79], v[66:67], v[80:81] op_sel:[1,1,0] op_sel_hi:[1,0,1] neg_lo:[1,0,0]
    v_pk_fma_f32 v[72:73], v[70:71], v[68:69], v[72:73] op_sel:[1,1,0] op_sel_hi:[1,0,1] neg_lo:[1,0,0]
    v_pk_fma_f32 v[76:77], v[74:75], v[68:69], v[76:77] op_sel:[1,1,0] op_sel_hi:[1,0,1] neg_lo:[1,0,0]
    v_cvt_pk_bf16_f32 v168, v70, -v71
    v_cvt_pk_bf16_f32 v169, v74, -v75
    v_cvt_pk_bf16_f32 v170, v78, v79
    ds_write_b32 v62, v168 offset:21648
    ds_write_b32 v62, v169 offset:22176
    ds_write_b32 v62, v170 offset:16896
    v_pk_mul_f32 v[78:79], v[80:81], v[66:67] op_sel:[0,0] op_sel_hi:[0,1]
    v_pk_mul_f32 v[70:71], v[72:73], v[68:69] op_sel:[0,0] op_sel_hi:[0,1]
    v_pk_mul_f32 v[74:75], v[76:77], v[68:69] op_sel:[0,0] op_sel_hi:[0,1]
    v_pk_fma_f32 v[78:79], v[80:81], v[66:67], v[78:79] op_sel:[1,1,0] op_sel_hi:[1,0,1] neg_lo:[1,0,0]
    v_pk_fma_f32 v[70:71], v[72:73], v[68:69], v[70:71] op_sel:[1,1,0] op_sel_hi:[1,0,1] neg_lo:[1,0,0]
    v_pk_fma_f32 v[74:75], v[76:77], v[68:69], v[74:75] op_sel:[1,1,0] op_sel_hi:[1,0,1] neg_lo:[1,0,0]
    v_cvt_pk_bf16_f32 v171, v72, -v73
    v_cvt_pk_bf16_f32 v172, v76, -v77
    v_cvt_pk_bf16_f32 v173, v80, v81
    ds_write_b32 v62, v171 offset:22704
    ds_write_b32 v62, v172 offset:23232
    ds_write_b32 v62, v173 offset:17424
    v_pk_mul_f32 v[80:81], v[78:79], v[66:67] op_sel:[0,0] op_sel_hi:[0,1]
    v_pk_mul_f32 v[72:73], v[70:71], v[68:69] op_sel:[0,0] op_sel_hi:[0,1]
    v_pk_mul_f32 v[76:77], v[74:75], v[68:69] op_sel:[0,0] op_sel_hi:[0,1]
    v_pk_fma_f32 v[80:81], v[78:79], v[66:67], v[80:81] op_sel:[1,1,0] op_sel_hi:[1,0,1] neg_lo:[1,0,0]
    v_pk_fma_f32 v[72:73], v[70:71], v[68:69], v[72:73] op_sel:[1,1,0] op_sel_hi:[1,0,1] neg_lo:[1,0,0]
    v_pk_fma_f32 v[76:77], v[74:75], v[68:69], v[76:77] op_sel:[1,1,0] op_sel_hi:[1,0,1] neg_lo:[1,0,0]
    v_cvt_pk_bf16_f32 v174, v70, -v71
    v_cvt_pk_bf16_f32 v175, v74, -v75
    v_cvt_pk_bf16_f32 v176, v78, v79
    ds_write_b32 v62, v174 offset:23760
    ds_write_b32 v62, v175 offset:24288
    ds_write_b32 v62, v176 offset:17952
    v_pk_mul_f32 v[78:79], v[80:81], v[66:67] op_sel:[0,0] op_sel_hi:[0,1]
    v_pk_mul_f32 v[70:71], v[72:73], v[68:69] op_sel:[0,0] op_sel_hi:[0,1]
    v_pk_mul_f32 v[74:75], v[76:77], v[68:69] op_sel:[0,0] op_sel_hi:[0,1]
    v_pk_fma_f32 v[78:79], v[80:81], v[66:67], v[78:79] op_sel:[1,1,0] op_sel_hi:[1,0,1] neg_lo:[1,0,0]
    v_pk_fma_f32 v[70:71], v[72:73], v[68:69], v[70:71] op_sel:[1,1,0] op_sel_hi:[1,0,1] neg_lo:[1,0,0]
    v_pk_fma_f32 v[74:75], v[76:77], v[68:69], v[74:75] op_sel:[1,1,0] op_sel_hi:[1,0,1] neg_lo:[1,0,0]
    v_cvt_pk_bf16_f32 v177, v72, -v73
    v_cvt_pk_bf16_f32 v178, v76, -v77
    v_cvt_pk_bf16_f32 v179, v80, v81
    ds_write_b32 v62, v177 offset:24816
    ds_write_b32 v62, v178 offset:25344
    ds_write_b32 v62, v179 offset:18480
    v_pk_mul_f32 v[80:81], v[78:79], v[66:67] op_sel:[0,0] op_sel_hi:[0,1]
    v_pk_mul_f32 v[72:73], v[70:71], v[68:69] op_sel:[0,0] op_sel_hi:[0,1]
    v_pk_mul_f32 v[76:77], v[74:75], v[68:69] op_sel:[0,0] op_sel_hi:[0,1]
    v_pk_fma_f32 v[80:81], v[78:79], v[66:67], v[80:81] op_sel:[1,1,0] op_sel_hi:[1,0,1] neg_lo:[1,0,0]
    v_pk_fma_f32 v[72:73], v[70:71], v[68:69], v[72:73] op_sel:[1,1,0] op_sel_hi:[1,0,1] neg_lo:[1,0,0]
    v_pk_fma_f32 v[76:77], v[74:75], v[68:69], v[76:77] op_sel:[1,1,0] op_sel_hi:[1,0,1] neg_lo:[1,0,0]
    v_cvt_pk_bf16_f32 v168, v70, -v71
    v_cvt_pk_bf16_f32 v169, v74, -v75
    v_cvt_pk_bf16_f32 v170, v78, v79
    ds_write_b32 v62, v168 offset:25872
    ds_write_b32 v62, v169 offset:26400
    ds_write_b32 v62, v170 offset:19008
    v_pk_mul_f32 v[78:79], v[80:81], v[66:67] op_sel:[0,0] op_sel_hi:[0,1]
    v_pk_mul_f32 v[70:71], v[72:73], v[68:69] op_sel:[0,0] op_sel_hi:[0,1]
    v_pk_mul_f32 v[74:75], v[76:77], v[68:69] op_sel:[0,0] op_sel_hi:[0,1]
    v_pk_fma_f32 v[78:79], v[80:81], v[66:67], v[78:79] op_sel:[1,1,0] op_sel_hi:[1,0,1] neg_lo:[1,0,0]
    v_pk_fma_f32 v[70:71], v[72:73], v[68:69], v[70:71] op_sel:[1,1,0] op_sel_hi:[1,0,1] neg_lo:[1,0,0]
    v_pk_fma_f32 v[74:75], v[76:77], v[68:69], v[74:75] op_sel:[1,1,0] op_sel_hi:[1,0,1] neg_lo:[1,0,0]
    v_cvt_pk_bf16_f32 v171, v72, -v73
    v_cvt_pk_bf16_f32 v172, v76, -v77
    v_cvt_pk_bf16_f32 v173, v80, v81
    ds_write_b32 v62, v171 offset:26928
    ds_write_b32 v62, v172 offset:27456
    ds_write_b32 v62, v173 offset:19536
    v_pk_mul_f32 v[80:81], v[78:79], v[66:67] op_sel:[0,0] op_sel_hi:[0,1]
    v_pk_mul_f32 v[72:73], v[70:71], v[68:69] op_sel:[0,0] op_sel_hi:[0,1]
    v_pk_mul_f32 v[76:77], v[74:75], v[68:69] op_sel:[0,0] op_sel_hi:[0,1]
    v_pk_fma_f32 v[80:81], v[78:79], v[66:67], v[80:81] op_sel:[1,1,0] op_sel_hi:[1,0,1] neg_lo:[1,0,0]
    v_pk_fma_f32 v[72:73], v[70:71], v[68:69], v[72:73] op_sel:[1,1,0] op_sel_hi:[1,0,1] neg_lo:[1,0,0]
    v_pk_fma_f32 v[76:77], v[74:75], v[68:69], v[76:77] op_sel:[1,1,0] op_sel_hi:[1,0,1] neg_lo:[1,0,0]
    v_cvt_pk_bf16_f32 v174, v70, -v71
    v_cvt_pk_bf16_f32 v175, v74, -v75
    v_cvt_pk_bf16_f32 v176, v78, v79
    ds_write_b32 v62, v174 offset:27984
    ds_write_b32 v62, v175 offset:28512
    ds_write_b32 v62, v176 offset:20064
    v_pk_mul_f32 v[78:79], v[80:81], v[66:67] op_sel:[0,0] op_sel_hi:[0,1]
    v_pk_fma_f32 v[78:79], v[80:81], v[66:67], v[78:79] op_sel:[1,1,0] op_sel_hi:[1,0,1] neg_lo:[1,0,0]
    v_cvt_pk_bf16_f32 v177, v72, -v73
    v_cvt_pk_bf16_f32 v178, v76, -v77
    v_cvt_pk_bf16_f32 v179, v80, v81
    ds_write_b32 v62, v177 offset:29040
    ds_write_b32 v62, v178 offset:29568
    ds_write_b32 v62, v179 offset:20592
    v_cvt_pk_bf16_f32 v168, v78, v79
    ds_write_b32 v62, v168 offset:21120
    s_waitcnt vmcnt(2)
    buffer_load_dwordx4 v[100:103], v45, s[64:67], 0 offen
    buffer_load_dwordx2 v[104:105], v45, s[64:67], 0 offen offset:16
    buffer_load_dwordx4 v[106:109], v46, s[64:67], 0 offen
    buffer_load_dwordx2 v[110:111], v46, s[64:67], 0 offen offset:16
    s_waitcnt vmcnt(4)
    s_branch L_kd
L_kb:
    v_mul_f32 v90, 0x3f800000, v16
    v_mul_f32 v67, 0x3f800000, v17
    v_mul_f32 v92, 0x43000000, v16
    v_mul_f32 v81, 0x43000000, v17
    v_mul_f32 v94, 0x43800000, v16
    v_mul_f32 v83, 0x43800000, v17
    v_mul_f32 v88, 0x44000000, v16
    v_mul_f32 v85, 0x44000000, v17
    v_fract_f32 v67, v67
    v_fract_f32 v81, v81
    v_fract_f32 v83, v83
    v_fract_f32 v85, v85
    v_exp_f32 v90, v90
    v_exp_f32 v92, v92
    v_exp_f32 v94, v94
    v_exp_f32 v88, v88
    v_cos_f32 v66, v67
    v_cos_f32 v80, v81
    v_cos_f32 v82, v83
    v_cos_f32 v84, v85
    v_sin_f32 v67, v67
    v_sin_f32 v81, v81
    v_sin_f32 v83, v83
    v_sin_f32 v85, v85
    v_pk_mul_f32 v[66:67], v[66:67], v[90:91] op_sel_hi:[1,0]
    v_pk_mul_f32 v[80:81], v[80:81], v[92:93] op_sel_hi:[1,0]
    v_pk_mul_f32 v[82:83], v[82:83], v[94:95] op_sel_hi:[1,0]
    v_pk_mul_f32 v[84:85], v[84:85], v[88:89] op_sel_hi:[1,0]
    v_mov_b32 v180, 0x3f80
    ds_write_b32 v62, v180
    v_pk_mul_f32 v[68:69], v[66:67], v[66:67] op_sel:[0,0] op_sel_hi:[0,1]
    v_pk_mul_f32 v[86:87], v[82:83], v[80:81] op_sel:[0,0] op_sel_hi:[0,1]
    v_pk_mul_f32 v[96:97], v[84:85], v[80:81] op_sel:[0,0] op_sel_hi:[0,1]
    v_pk_mul_f32 v[98:99], v[84:85], v[82:83] op_sel:[0,0] op_sel_hi:[0,1]
    v_pk_fma_f32 v[68:69], v[66:67], v[66:67], v[68:69] op_sel:[1,1,0] op_sel_hi:[1,0,1] neg_lo:[1,0,0]
    v_pk_fma_f32 v[86:87], v[82:83], v[80:81], v[86:87] op_sel:[1,1,0] op_sel_hi:[1,0,1] neg_lo:[1,0,0]
    v_pk_fma_f32 v[96:97], v[84:85], v[80:81], v[96:97] op_sel:[1,1,0] op_sel_hi:[1,0,1] neg_lo:[1,0,0]
    v_pk_fma_f32 v[98:99], v[84:85], v[82:83], v[98:99] op_sel:[1,1,0] op_sel_hi:[1,0,1] neg_lo:[1,0,0]
    v_cvt_pk_bf16_f32 v169, v66, v67
    v_cvt_pk_bf16_f32 v170, v80, v81
    v_cvt_pk_bf16_f32 v171, v82, v83
    v_cvt_pk_bf16_f32 v172, v84, v85
    ds_write_b32 v62, v169 offset:528
    ds_write_b32 v62, v170 offset:4224
    ds_write_b32 v62, v171 offset:8448
    ds_write_b32 v62, v172 offset:12672
    v_pk_mul_f32 v[70:71], v[68:69], v[66:67] op_sel:[0,0] op_sel_hi:[0,1]
    v_pk_mul_f32 v[72:73], v[68:69], v[68:69] op_sel:[0,0] op_sel_hi:[0,1]
    v_pk_mul_f32 v[100:101], v[98:99], v[80:81] op_sel:[0,0] op_sel_hi:[0,1]
    v_pk_mul_f32 v[102:103], v[80:81], v[66:67] op_sel:[0,0] op_sel_hi:[0,1]
    v_pk_mul_f32 v[104:105], v[80:81], v[68:69] op_sel:[0,0] op_sel_hi:[0,1]
    v_pk_mul_f32 v[106:107], v[82:83], v[68:69] op_sel:[0,0] op_sel_hi:[0,1]
    v_pk_mul_f32 v[108:109], v[86:87], v[68:69] op_sel:[0,0] op_sel_hi:[0,1]
    v_pk_fma_f32 v[70:71], v[68:69], v[66:67], v[70:71] op_sel:[1,1,0] op_sel_hi:[1,0,1] neg_lo:[1,0,0]
    v_pk_fma_f32 v[72:73], v[68:69], v[68:69], v[72:73] op_sel:[1,1,0] op_sel_hi:[1,0,1] neg_lo:[1,0,0]
    v_pk_fma_f32 v[100:101], v[98:99], v[80:81], v[100:101] op_sel:[1,1,0] op_sel_hi:[1,0,1] neg_lo:[1,0,0]
    v_pk_fma_f32 v[102:103], v[80:81], v[66:67], v[102:103] op_sel:[1,1,0] op_sel_hi:[1,0,1] neg_lo:[1,0,0]
    v_pk_fma_f32 v[104:105], v[80:81], v[68:69], v[104:105] op_sel:[1,1,0] op_sel_hi:[1,0,1] neg_lo:[1,0,0]
    v_pk_fma_f32 v[106:107], v[82:83], v[68:69], v[106:107] op_sel:[1,1,0] op_sel_hi:[1,0,1] neg_lo:[1,0,0]
    v_pk_fma_f32 v[108:109], v[86:87], v[68:69], v[108:109] op_sel:[1,1,0] op_sel_hi:[1,0,1] neg_lo:[1,0,0]
    v_cvt_pk_bf16_f32 v173, v68, v69
    v_cvt_pk_bf16_f32 v174, v86, v87
    v_cvt_pk_bf16_f32 v175, v96, v97
    v_cvt_pk_bf16_f32 v176, v98, v99
    ds_write_b32 v62, v173 offset:1056
    ds_write_b32 v62, v174 offset:10560
    ds_write_b32 v62, v175 offset:13728
    ds_write_b32 v62, v176 offset:14784
    v_pk_mul_f32 v[74:75], v[72:73], v[66:67] op_sel:[0,0] op_sel_hi:[0,1]
    v_pk_mul_f32 v[76:77], v[72:73], v[68:69] op_sel:[0,0] op_sel_hi:[0,1]
    v_pk_mul_f32 v[78:79], v[72:73], v[70:71] op_sel:[0,0] op_sel_hi:[0,1]
    v_pk_mul_f32 v[110:111], v[84:85], v[72:73] op_sel:[0,0] op_sel_hi:[0,1]
    v_pk_mul_f32 v[112:113], v[96:97], v[72:73] op_sel:[0,0] op_sel_hi:[0,1]
    v_pk_mul_f32 v[114:115], v[98:99], v[72:73] op_sel:[0,0] op_sel_hi:[0,1]
    v_pk_mul_f32 v[116:117], v[100:101], v[72:73] op_sel:[0,0] op_sel_hi:[0,1]
    v_pk_fma_f32 v[74:75], v[72:73], v[66:67], v[74:75] op_sel:[1,1,0] op_sel_hi:[1,0,1] neg_lo:[1,0,0]
    v_pk_fma_f32 v[76:77], v[72:73], v[68:69], v[76:77] op_sel:[1,1,0] op_sel_hi:[1,0,1] neg_lo:[1,0,0]
    v_pk_fma_f32 v[78:79], v[72:73], v[70:71], v[78:79] op_sel:[1,1,0] op_sel_hi:[1,0,1] neg_lo:[1,0,0]
    v_pk_fma_f32 v[110:111], v[84:85], v[72:73], v[110:111] op_sel:[1,1,0] op_sel_hi:[1,0,1] neg_lo:[1,0,0]
    v_pk_fma_f32 v[112:113], v[96:97], v[72:73], v[112:113] op_sel:[1,1,0] op_sel_hi:[1,0,1] neg_lo:[1,0,0]
    v_pk_fma_f32 v[114:115], v[98:99], v[72:73], v[114:115] op_sel:[1,1,0] op_sel_hi:[1,0,1] neg_lo:[1,0,0]
    v_pk_fma_f32 v[116:117], v[100:101], v[72:73], v[116:117] op_sel:[1,1,0] op_sel_hi:[1,0,1] neg_lo:[1,0,0]
    v_cvt_pk_bf16_f32 v177, v70, v71
    v_cvt_pk_bf16_f32 v178, v72, v73
    v_cvt_pk_bf16_f32 v179, v100, v101
    v_cvt_pk_bf16_f32 v168, v102, v103
    v_cvt_pk_bf16_f32 v169, v104, v105
    v_cvt_pk_bf16_f32 v170, v106, v107
    v_cvt_pk_bf16_f32 v171, v108, v109
    ds_write_b32 v62, v177 offset:1584
    ds_write_b32 v62, v178 offset:2112
    ds_write_b32 v62, v179 offset:15840
    ds_write_b32 v62, v168 offset:4752
    ds_write_b32 v62, v169 offset:5280
    ds_write_b32 v62, v170 offset:8976
    ds_write_b32 v62, v171 offset:11088
    v_pk_mul_f32 v[96:97], v[80:81], v[70:71] op_sel:[0,0] op_sel_hi:[0,1]
    v_pk_mul_f32 v[98:99], v[80:81], v[72:73] op_sel:[0,0] op_sel_hi:[0,1]
    v_pk_mul_f32 v[102:103], v[82:83], v[72:73] op_sel:[0,0] op_sel_hi:[0,1]
    v_pk_mul_f32 v[104:105], v[86:87], v[72:73] op_sel:[0,0] op_sel_hi:[0,1]
    v_pk_fma_f32 v[96:97], v[80:81], v[70:71], v[96:97] op_sel:[1,1,0] op_sel_hi:[1,0,1] neg_lo:[1,0,0]
    v_pk_fma_f32 v[98:99], v[80:81], v[72:73], v[98:99] op_sel:[1,1,0] op_sel_hi:[1,0,1] neg_lo:[1,0,0]
    v_pk_fma_f32 v[102:103], v[82:83], v[72:73], v[102:103] op_sel:[1,1,0] op_sel_hi:[1,0,1] neg_lo:[1,0,0]
    v_pk_fma_f32 v[104:105], v[86:87], v[72:73], v[104:105] op_sel:[1,1,0] op_sel_hi:[1,0,1] neg_lo:[1,0,0]
    v_cvt_pk_bf16_f32 v172, v74, v75
    v_cvt_pk_bf16_f32 v173, v76, v77
    v_cvt_pk_bf16_f32 v174, v78, v79
    v_cvt_pk_bf16_f32 v175, v110, v111
    v_cvt_pk_bf16_f32 v176, v112, v113
    v_cvt_pk_bf16_f32 v177, v114, v115
    v_cvt_pk_bf16_f32 v178, v116, v117
    ds_write_b32 v62, v172 offset:2640
    ds_write_b32 v62, v173 offset:3168
    ds_write_b32 v62, v174 offset:3696
    ds_write_b32 v62, v175 offset:13200
    ds_write_b32 v62, v176 offset:14256
    ds_write_b32 v62, v177 offset:15312
    ds_write_b32 v62, v178 offset:16368
    v_pk_mul_f32 v[100:101], v[80:81], v[74:75] op_sel:[0,0] op_sel_hi:[0,1]
    v_pk_mul_f32 v[106:107], v[80:81], v[76:77] op_sel:[0,0] op_sel_hi:[0,1]
    v_pk_mul_f32 v[108:109], v[80:81], v[78:79] op_sel:[0,0] op_sel_hi:[0,1]
    v_pk_mul_f32 v[110:111], v[82:83], v[76:77] op_sel:[0,0] op_sel_hi:[0,1]
    v_pk_mul_f32 v[112:113], v[86:87], v[76:77] op_sel:[0,0] op_sel_hi:[0,1]
    v_pk_fma_f32 v[100:101], v[80:81], v[74:75], v[100:101] op_sel:[1,1,0] op_sel_hi:[1,0,1] neg_lo:[1,0,0]
    v_pk_fma_f32 v[106:107], v[80:81], v[76:77], v[106:107] op_sel:[1,1,0] op_sel_hi:[1,0,1] neg_lo:[1,0,0]
    v_pk_fma_f32 v[108:109], v[80:81], v[78:79], v[108:109] op_sel:[1,1,0] op_sel_hi:[1,0,1] neg_lo:[1,0,0]
    v_pk_fma_f32 v[110:111], v[82:83], v[76:77], v[110:111] op_sel:[1,1,0] op_sel_hi:[1,0,1] neg_lo:[1,0,0]
    v_pk_fma_f32 v[112:113], v[86:87], v[76:77], v[112:113] op_sel:[1,1,0] op_sel_hi:[1,0,1] neg_lo:[1,0,0]
    v_cvt_pk_bf16_f32 v179, v96, v97
    v_cvt_pk_bf16_f32 v168, v98, v99
    v_cvt_pk_bf16_f32 v169, v102, v103
    v_cvt_pk_bf16_f32 v170, v104, v105
    ds_write_b32 v62, v179 offset:5808
    ds_write_b32 v62, v168 offset:6336
    ds_write_b32 v62, v169 offset:9504
    ds_write_b32 v62, v170 offset:11616
    v_cvt_pk_bf16_f32 v171, v100, v101
    v_cvt_pk_bf16_f32 v172, v106, v107
    v_cvt_pk_bf16_f32 v173, v108, v109
    v_cvt_pk_bf16_f32 v174, v110, v111
    v_cvt_pk_bf16_f32 v175, v112, v113
    ds_write_b32 v62, v171 offset:6864
    ds_write_b32 v62, v172 offset:7392
    ds_write_b32 v62, v173 offset:7920
    ds_write_b32 v62, v174 offset:10032
    ds_write_b32 v62, v175 offset:12144
    s_waitcnt vmcnt(0)
L_kd:
    ds_write_b128 v56, v[128:131] offset:3072
    ds_write_b128 v58, v[164:167]
    s_lshl_b32 s58, s5, 3
    s_mov_b32 s56, 151718926
    s_mov_b32 s57, 33817863
    s_lshr_b64 s[56:57], s[56:57], s58
    s_and_b32 s69, s56, 0xff
    s_lshl_b32 s58, s5, 3
    s_mov_b32 s56, 50462976
    s_mov_b32 s57, 134678021
    s_lshr_b64 s[56:57], s[56:57], s58
    s_and_b32 s68, s56, 0xff
    s_lshl_b32 s58, s5, 3
    s_mov_b32 s56, 100925952
    s_mov_b32 s57, 235670024
    s_lshr_b64 s[56:57], s[56:57], s58
    s_and_b32 s9, s56, 0xff
    s_lshl_b32 s58, s5, 3
    s_mov_b32 s56, 84148737
    s_mov_b32 s57, 168363782
    s_lshr_b64 s[56:57], s[56:57], s58
    s_and_b32 s8, s56, 0xff
    s_lshl_b32 s58, s5, 3
    s_mov_b32 s56, 0
    s_mov_b32 s57, 0
    s_lshr_b64 s[56:57], s[56:57], s58
    s_and_b32 s11, s56, 0xff
    s_lshl_b32 s58, s5, 3
    s_mov_b32 s56, 117901063
    s_mov_b32 s57, 117901063
    s_lshr_b64 s[56:57], s[56:57], s58
    s_and_b32 s10, s56, 0xff
    s_lshl_b32 s58, s5, 3
    s_mov_b32 s56, 151718926
    s_mov_b32 s57, 33817863
    s_lshr_b64 s[56:57], s[56:57], s58
    s_and_b32 s55, s56, 0xff
    v_lshlrev_b32 v64, 16, v144
    v_and_b32 v65, 0xffff0000, v144
    v_lshlrev_b32 v66, 16, v145
    v_and_b32 v67, 0xffff0000, v145
    v_lshlrev_b32 v68, 16, v146
    v_and_b32 v69, 0xffff0000, v146
    v_lshlrev_b32 v70, 16, v147
    v_and_b32 v71, 0xffff0000, v147
    s_mov_b32 s56, 0x05040100
    s_mov_b32 s58, 0x07060302
    s_waitcnt lgkmcnt(0)
    s_barrier
    ds_read_b128 v[132:135], v56 offset:2048
    ds_read_b128 v[136:139], v56 offset:1024
    ds_read_b128 v[140:143], v56 offset:0
    ds_read_b128 v[148:151], v57 offset:0
    ds_read_b128 v[152:155], v57 offset:1056
    ds_read_b128 v[156:159], v57 offset:2112
    ds_read_b128 v[160:163], v57 offset:3168
    s_add_u32 s54, s54, 1
    s_waitcnt lgkmcnt(4)
    v_perm_b32 v72, v132, v128, s56
    v_perm_b32 v73, v140, v136, s56
    v_perm_b32 v74, v132, v128, s58
    v_perm_b32 v75, v140, v136, s58
    v_perm_b32 v76, v133, v129, s56
    v_perm_b32 v77, v141, v137, s56
    v_perm_b32 v78, v133, v129, s58
    v_perm_b32 v79, v141, v137, s58
    v_perm_b32 v80, v134, v130, s56
    v_perm_b32 v81, v142, v138, s56
    v_perm_b32 v82, v134, v130, s58
    v_perm_b32 v83, v142, v138, s58
    v_perm_b32 v84, v135, v131, s56
    v_perm_b32 v85, v143, v139, s56
    v_perm_b32 v86, v135, v131, s58
    v_perm_b32 v87, v143, v139, s58
    s_waitcnt lgkmcnt(3)
    v_dot2_f32_bf16 v48, v72, v148, 0
    v_dot2_f32_bf16 v49, v74, v150, 0
    s_waitcnt lgkmcnt(2)
    v_dot2_f32_bf16 v50, v76, v152, 0
    v_dot2_f32_bf16 v51, v78, v154, 0
    s_waitcnt lgkmcnt(1)
    v_dot2_f32_bf16 v52, v80, v156, 0
    v_dot2_f32_bf16 v53, v82, v158, 0
    s_waitcnt lgkmcnt(0)
    v_dot2_f32_bf16 v54, v84, v160, 0
    v_dot2_f32_bf16 v55, v86, v162, 0
    v_dot2_f32_bf16 v48, v73, v149, v48
    v_dot2_f32_bf16 v49, v75, v151, v49
    v_dot2_f32_bf16 v50, v77, v153, v50
    v_dot2_f32_bf16 v51, v79, v155, v51
    v_dot2_f32_bf16 v52, v81, v157, v52
    v_dot2_f32_bf16 v53, v83, v159, v53
    v_dot2_f32_bf16 v54, v85, v161, v54
    v_dot2_f32_bf16 v55, v87, v163, v55
    v_pk_mul_f32 v[48:49], v[48:49], v[64:65]
    v_pk_mul_f32 v[50:51], v[50:51], v[66:67]
    v_pk_mul_f32 v[52:53], v[52:53], v[68:69]
    v_pk_mul_f32 v[54:55], v[54:55], v[70:71]
    v_lshl_add_u32 v59, v1, 4, s6
    global_load_dwordx4 v[24:27], v59, s[16:17]
    v_cvt_pk_bf16_f32 v40, v48, v49
    v_cvt_pk_bf16_f32 v41, v50, v51
    v_cvt_pk_bf16_f32 v42, v52, v53
    v_cvt_pk_bf16_f32 v43, v54, v55
    ds_write_b128 v6, v[40:43]
    s_lshr_b32 s56, s3, 1
    s_waitcnt lgkmcnt(0)
    s_barrier
    s_cmp_eq_u32 s56, 2
    s_cbranch_scc1 Lss_1
    ds_read_b64_tr_b16 v[44:45], v7 offset:4608
    ds_read_b64_tr_b16 v[46:47], v7 offset:256
    s_cmp_eq_u32 s56, 3
    s_cbranch_scc0 Lso_2
    ds_read_b64_tr_b16 v[48:49], v7 offset:4352
    ds_read_b64_tr_b16 v[50:51], v7
    s_waitcnt lgkmcnt(0)
    global_store_dwordx4 v3, v[48:51], s[60:61] offset:-2048 sc1
    v_add3_u32 v52, v48, v49, v50
    v_add3_u32 v52, v52, v51, s54
    global_store_dword v4, v52, s[52:53] offset:-512 sc1
Lso_2:
    s_waitcnt lgkmcnt(0)
    global_store_dwordx4 v3, v[44:47], s[60:61] sc1
    v_add3_u32 v53, v44, v45, v46
    v_add3_u32 v53, v53, v47, s54
    global_store_dword v4, v53, s[52:53] sc1
Lss_1:
    s_cmp_lt_u32 s3, 4
    s_cbranch_scc1 L_mssm
    s_cmp_ge_u32 s3, 6
    s_cbranch_scc1 L_hk2
    s_sleep 30
    global_load_dwordx4 v[196:199], v228, s[60:61] sc1
    global_load_dword v212, v232, s[52:53] sc1
    global_load_dwordx4 v[200:203], v229, s[60:61] sc1
    global_load_dword v213, v233, s[52:53] sc1
    global_load_dwordx4 v[204:207], v230, s[60:61] sc1
    global_load_dword v214, v234, s[52:53] sc1
    global_load_dwordx4 v[208:211], v231, s[60:61] sc1
    global_load_dword v215, v235, s[52:53] sc1
    s_branch L_loop
L_hk2:
    ds_read_b128 v[64:67], v210 offset:0
    ds_read_b128 v[68:71], v210 offset:64
    ds_read_b128 v[72:75], v210 offset:128
    ds_read_b128 v[76:79], v210 offset:192
    ds_read_b128 v[80:83], v210 offset:256
    ds_read_b128 v[84:87], v210 offset:320
    ds_read_b128 v[88:91], v210 offset:384
    ds_read_b128 v[92:95], v210 offset:448
    ds_read_b128 v[96:99], v208 offset:0
    ds_read_b128 v[128:131], v208 offset:8448
    ds_read_b128 v[160:163], v209 offset:16896
    ds_read_b128 v[100:103], v208 offset:64
    ds_read_b128 v[132:135], v208 offset:8512
    ds_read_b128 v[164:167], v209 offset:16960
    ds_read_b128 v[104:107], v208 offset:128
    ds_read_b128 v[136:139], v208 offset:8576
    ds_read_b128 v[168:171], v209 offset:17024
    ds_read_b128 v[108:111], v208 offset:192
    ds_read_b128 v[140:143], v208 offset:8640
    ds_read_b128 v[172:175], v209 offset:17088
    ds_read_b128 v[112:115], v208 offset:256
    ds_read_b128 v[144:147], v208 offset:8704
    ds_read_b128 v[176:179], v209 offset:17152
    ds_read_b128 v[116:119], v208 offset:320
    ds_read_b128 v[148:151], v208 offset:8768
    ds_read_b128 v[180:183], v209 offset:17216
    ds_read_b128 v[120:123], v208 offset:384
    ds_read_b128 v[152:155], v208 offset:8832
    ds_read_b128 v[184:187], v209 offset:17280
    ds_read_b128 v[124:127], v208 offset:448
    ds_read_b128 v[156:159], v208 offset:8896
    ds_read_b128 v[188:191], v209 offset:17344
    s_and_b32 s58, s3, 1
    s_lshl_b32 s62, s15, 16
    s_and_b32 s63, s15, 0xffff0000
    s_cmp_eq_u32 s58, 0
    s_cselect_b32 s62, s62, s63
    v_writelane_b32 v240, s62, 0
    s_waitcnt lgkmcnt(15)
    s_nop 0
    v_mfma_f32_16x16x32_bf16 v[240:243], v[96:99], v[64:67], v[240:243]
    v_mfma_f32_16x16x32_bf16 v[244:247], v[128:131], v[64:67], v[244:247]
    v_mfma_f32_16x16x32_bf16 v[248:251], v[160:163], v[64:67], v[248:251]
    s_waitcnt lgkmcnt(15)
    v_mfma_f32_16x16x32_bf16 v[240:243], v[100:103], v[68:71], v[240:243]
    v_mfma_f32_16x16x32_bf16 v[244:247], v[132:135], v[68:71], v[244:247]
    v_mfma_f32_16x16x32_bf16 v[248:251], v[164:167], v[68:71], v[248:251]
    s_waitcnt lgkmcnt(15)
    v_mfma_f32_16x16x32_bf16 v[240:243], v[104:107], v[72:75], v[240:243]
    v_mfma_f32_16x16x32_bf16 v[244:247], v[136:139], v[72:75], v[244:247]
    v_mfma_f32_16x16x32_bf16 v[248:251], v[168:171], v[72:75], v[248:251]
    s_waitcnt lgkmcnt(12)
    v_mfma_f32_16x16x32_bf16 v[240:243], v[108:111], v[76:79], v[240:243]
    v_mfma_f32_16x16x32_bf16 v[244:247], v[140:143], v[76:79], v[244:247]
    v_mfma_f32_16x16x32_bf16 v[248:251], v[172:175], v[76:79], v[248:251]
    s_waitcnt lgkmcnt(9)
    v_mfma_f32_16x16x32_bf16 v[240:243], v[112:115], v[80:83], v[240:243]
    v_mfma_f32_16x16x32_bf16 v[244:247], v[144:147], v[80:83], v[244:247]
    v_mfma_f32_16x16x32_bf16 v[248:251], v[176:179], v[80:83], v[248:251]
    s_waitcnt lgkmcnt(6)
    v_mfma_f32_16x16x32_bf16 v[240:243], v[116:119], v[84:87], v[240:243]
    v_mfma_f32_16x16x32_bf16 v[244:247], v[148:151], v[84:87], v[244:247]
    v_mfma_f32_16x16x32_bf16 v[248:251], v[180:183], v[84:87], v[248:251]
    s_waitcnt lgkmcnt(3)
    v_mfma_f32_16x16x32_bf16 v[240:243], v[120:123], v[88:91], v[240:243]
    v_mfma_f32_16x16x32_bf16 v[244:247], v[152:155], v[88:91], v[244:247]
    v_mfma_f32_16x16x32_bf16 v[248:251], v[184:187], v[88:91], v[248:251]
    s_waitcnt lgkmcnt(0)
    v_mfma_f32_16x16x32_bf16 v[240:243], v[124:127], v[92:95], v[240:243]
    v_mfma_f32_16x16x32_bf16 v[244:247], v[156:159], v[92:95], v[244:247]
    v_mfma_f32_16x16x32_bf16 v[248:251], v[188:191], v[92:95], v[248:251]
    s_nop 5
    v_cvt_pk_bf16_f32 v54, v240, v241
    v_cvt_pk_bf16_f32 v55, v242, v243
    ds_write_b16 v216, v54
    ds_write_b16_d16_hi v217, v54
    ds_write_b16 v218, v55
    ds_write_b16_d16_hi v219, v55
    v_cvt_pk_bf16_f32 v56, v244, v245
    v_cvt_pk_bf16_f32 v57, v246, v247
    ds_write_b16 v220, v56
    ds_write_b16_d16_hi v221, v56
    ds_write_b16 v222, v57
    ds_write_b16_d16_hi v223, v57
    v_cvt_pk_bf16_f32 v58, v248, v249
    v_cvt_pk_bf16_f32 v59, v250, v251
    ds_write_b16 v224, v58
    ds_write_b16_d16_hi v225, v58
    ds_write_b16 v226, v59
    ds_write_b16_d16_hi v227, v59
    s_mov_b64 exec, 1
    ds_add_u32 v15, v14 offset:68
    s_mov_b64 exec, -1
    s_waitcnt vmcnt(4)
    v_lshlrev_b32 v16, 16, v24
    v_and_b32 v17, 0xffff0000, v24
    v_lshlrev_b32 v18, 16, v25
    v_and_b32 v19, 0xffff0000, v25
    v_lshlrev_b32 v20, 16, v26
    v_and_b32 v21, 0xffff0000, v26
    v_lshlrev_b32 v22, 16, v27
    v_and_b32 v23, 0xffff0000, v27
    v_mov_b32 v104, 0x3b000000
    v_mov_b32 v105, 0x3727c5ac
    v_pk_add_f32 v[96:97], v[16:17], v[18:19]
    v_pk_mul_f32 v[100:101], v[16:17], v[16:17]
    v_pk_add_f32 v[98:99], v[20:21], v[22:23]
    v_pk_mul_f32 v[102:103], v[20:21], v[20:21]
    v_pk_fma_f32 v[100:101], v[18:19], v[18:19], v[100:101]
    v_pk_fma_f32 v[102:103], v[22:23], v[22:23], v[102:103]
    v_pk_add_f32 v[96:97], v[96:97], v[98:99]
    v_pk_add_f32 v[100:101], v[100:101], v[102:103]
    v_add_f32 v96, v96, v97
    v_add_f32 v100, v100, v101
    s_nop 1
    v_permlane32_swap_b32 v96, v100
    v_add_f32 v96, v96, v100
    s_nop 1
    v_add_f32_dpp v96, v96, v96 row_ror:8 row_mask:0xf bank_mask:0xf
    s_nop 1
    v_add_f32_dpp v96, v96, v96 row_ror:4 row_mask:0xf bank_mask:0xf
    s_nop 1
    v_add_f32_dpp v96, v96, v96 row_ror:2 row_mask:0xf bank_mask:0xf
    s_nop 1
    v_add_f32_dpp v96, v96, v96 row_ror:1 row_mask:0xf bank_mask:0xf
    s_nop 1
    v_add_f32_dpp v96, v96, v96 row_bcast:15 row_mask:0xa bank_mask:0xf
    s_nop 0
    v_readlane_b32 s62, v96, 31
    v_readlane_b32 s63, v96, 63
    s_nop 0
    v_mul_f32 v96, s62, v104
    v_fma_f32 v98, s63, v104, v105
    v_fma_f32 v98, -v96, v96, v98
    v_max_f32 v98, v105, v98
    v_rsq_f32 v98, v98
    s_nop 0
    v_mul_f32_e64 v96, v96, -v98
    v_pk_fma_f32 v[112:113], v[16:17], v[98:99], v[96:97] op_sel_hi:[1,0,0]
    v_pk_fma_f32 v[114:115], v[18:19], v[98:99], v[96:97] op_sel_hi:[1,0,0]
    v_pk_fma_f32 v[116:117], v[20:21], v[98:99], v[96:97] op_sel_hi:[1,0,0]
    v_pk_fma_f32 v[118:119], v[22:23], v[98:99], v[96:97] op_sel_hi:[1,0,0]
    v_mov_b32 v196, v112
    v_mov_b32 v197, v113
    v_mov_b32 v198, v114
    v_mov_b32 v199, v115
    v_mov_b32 v200, v116
    v_mov_b32 v201, v117
    v_mov_b32 v202, v118
    v_mov_b32 v203, v119
    s_branch L_loop
L_hk3:
Ls_3:
    ds_read_b32 v41, v15 offset:68
    s_waitcnt lgkmcnt(0)
    v_cmp_le_u32 vcc, 2, v41
    s_cbranch_vccnz Lsd_4
    s_sub_u32 s12, s12, 1
    s_cbranch_scc1 L_exit
    s_branch Ls_3
Lsd_4:
    ds_read_u16 v76, v28 offset:0
    ds_read_u16 v77, v29 offset:0
    ds_read_u16 v78, v30 offset:0
    ds_read_u16 v79, v31 offset:0
    ds_read_u16 v80, v32 offset:0
    ds_read_u16 v81, v33 offset:0
    ds_read_u16 v82, v34 offset:0
    ds_read_u16 v83, v35 offset:0
    ds_read_u16 v84, v36 offset:0
    ds_read_u16 v85, v37 offset:0
    ds_read_u16 v86, v38 offset:0
    ds_read_u16 v87, v39 offset:0
    ds_read_u16 v100, v28 offset:4896
    ds_read_u16 v101, v29 offset:4896
    ds_read_u16 v102, v30 offset:4896
    ds_read_u16 v103, v31 offset:4896
    ds_read_u16 v104, v32 offset:4896
    ds_read_u16 v105, v33 offset:4896
    ds_read_u16 v106, v34 offset:4896
    ds_read_u16 v107, v35 offset:4896
    ds_read_u16 v108, v36 offset:4896
    ds_read_u16 v109, v37 offset:4896
    ds_read_u16 v110, v38 offset:4896
    ds_read_u16 v111, v39 offset:4896
    s_waitcnt lgkmcnt(12)
    v_lshl_or_b32 v64, v77, 16, v76
    v_lshl_or_b32 v65, v79, 16, v78
    v_lshl_or_b32 v66, v81, 16, v80
    v_lshl_or_b32 v67, v83, 16, v82
    v_lshl_or_b32 v68, v85, 16, v84
    v_lshl_or_b32 v69, v87, 16, v86
    s_waitcnt lgkmcnt(0)
    v_lshl_or_b32 v70, v101, 16, v100
    v_lshl_or_b32 v71, v103, 16, v102
    v_lshl_or_b32 v72, v105, 16, v104
    v_lshl_or_b32 v73, v107, 16, v106
    v_lshl_or_b32 v74, v109, 16, v108
    v_lshl_or_b32 v75, v111, 16, v110
    s_cmp_eq_u32 s3, 4
    s_cbranch_scc0 Lbz_5
    v_lshrrev_b32 v76, 1, v1
    v_mul_u32_u24 v76, 4160, v76
    v_and_b32 v77, 1, v1
    v_lshl_add_u32 v76, v77, 4, v76
    v_lshlrev_b32 v77, 4, v1
    v_sub_u32 v77, v239, v77
    v_add_u32 v76, v76, v77
    v_mov_b32 v80, 0
    v_mov_b32 v81, 0
    v_mov_b32 v82, 0
    v_mov_b32 v83, 0
    v_alignbit_b32 v77, v65, v64, 16
    v_lshlrev_b32 v78, 16, v64
    s_mov_b64 exec, 0xff
    ds_write_b128 v76, v[80:83] offset:0
    s_mov_b64 exec, 1
    ds_write_b32 v239, v78 offset:4188
    ds_write_b32 v239, v64 offset:8348
    ds_write_b32 v239, v78 offset:12504
    ds_write_b32 v239, v77 offset:12508
    s_mov_b64 exec, -1
Lbz_5:
    ds_write_b128 v239, v[64:67] offset:32
    v_alignbit_b32 v76, v65, v64, 16
    v_alignbit_b32 v77, v66, v65, 16
    v_alignbit_b32 v78, v67, v66, 16
    v_alignbit_b32 v79, v68, v67, 16
    ds_write_b128 v239, v[76:79] offset:4192
    v_mov_b32 v80, v65
    v_mov_b32 v81, v66
    v_mov_b32 v82, v67
    v_mov_b32 v83, v68
    ds_write_b128 v239, v[80:83] offset:8352
    v_mov_b32 v84, v77
    v_mov_b32 v85, v78
    v_mov_b32 v86, v79
    v_alignbit_b32 v87, v69, v68, 16
    ds_write_b128 v239, v[84:87] offset:12512
    s_cmp_eq_u32 s3, 4
    s_cbranch_scc0 Lbz_6
    v_lshrrev_b32 v88, 1, v1
    v_mul_u32_u24 v88, 4160, v88
    v_and_b32 v89, 1, v1
    v_lshl_add_u32 v88, v89, 4, v88
    v_lshlrev_b32 v89, 4, v1
    v_sub_u32 v89, v239, v89
    v_add_u32 v88, v88, v89
    v_mov_b32 v92, 0
    v_mov_b32 v93, 0
    v_mov_b32 v94, 0
    v_mov_b32 v95, 0
    v_alignbit_b32 v89, v71, v70, 16
    v_lshlrev_b32 v90, 16, v70
    s_mov_b64 exec, 0xff
    ds_write_b128 v88, v[92:95] offset:16640
    s_mov_b64 exec, 1
    ds_write_b32 v239, v90 offset:20828
    ds_write_b32 v239, v70 offset:24988
    ds_write_b32 v239, v90 offset:29144
    ds_write_b32 v239, v89 offset:29148
    s_mov_b64 exec, -1
Lbz_6:
    ds_write_b128 v239, v[70:73] offset:16672
    v_alignbit_b32 v88, v71, v70, 16
    v_alignbit_b32 v89, v72, v71, 16
    v_alignbit_b32 v90, v73, v72, 16
    v_alignbit_b32 v91, v74, v73, 16
    ds_write_b128 v239, v[88:91] offset:20832
    v_mov_b32 v92, v71
    v_mov_b32 v93, v72
    v_mov_b32 v94, v73
    v_mov_b32 v95, v74
    ds_write_b128 v239, v[92:95] offset:24992
    v_mov_b32 v96, v89
    v_mov_b32 v97, v90
    v_mov_b32 v98, v91
    v_alignbit_b32 v99, v75, v74, 16
    ds_write_b128 v239, v[96:99] offset:29152
    v_mov_b32 v32, v196
    v_mov_b32 v33, v197
    v_mov_b32 v34, v198
    v_mov_b32 v35, v199
    v_mov_b32 v36, v200
    v_mov_b32 v37, v201
    v_mov_b32 v38, v202
    v_mov_b32 v39, v203
    s_branch L_post2
    s_cmp_ge_u32 s3, 6
    s_cbranch_scc0 L_loop
    s_waitcnt vmcnt(4)
    v_lshlrev_b32 v16, 16, v24
    v_and_b32 v17, 0xffff0000, v24
    v_lshlrev_b32 v18, 16, v25
    v_and_b32 v19, 0xffff0000, v25
    v_lshlrev_b32 v20, 16, v26
    v_and_b32 v21, 0xffff0000, v26
    v_lshlrev_b32 v22, 16, v27
    v_and_b32 v23, 0xffff0000, v27
    v_mov_b32 v104, 0x3b000000
    v_mov_b32 v105, 0x3727c5ac
    v_pk_add_f32 v[96:97], v[16:17], v[18:19]
    v_pk_mul_f32 v[100:101], v[16:17], v[16:17]
    v_pk_add_f32 v[98:99], v[20:21], v[22:23]
    v_pk_mul_f32 v[102:103], v[20:21], v[20:21]
    v_pk_fma_f32 v[100:101], v[18:19], v[18:19], v[100:101]
    v_pk_fma_f32 v[102:103], v[22:23], v[22:23], v[102:103]
    v_pk_add_f32 v[96:97], v[96:97], v[98:99]
    v_pk_add_f32 v[100:101], v[100:101], v[102:103]
    v_add_f32 v96, v96, v97
    v_add_f32 v100, v100, v101
    s_nop 1
    v_permlane32_swap_b32 v96, v100
    v_add_f32 v96, v96, v100
    s_nop 1
    v_add_f32_dpp v96, v96, v96 row_ror:8 row_mask:0xf bank_mask:0xf
    s_nop 1
    v_add_f32_dpp v96, v96, v96 row_ror:4 row_mask:0xf bank_mask:0xf
    s_nop 1
    v_add_f32_dpp v96, v96, v96 row_ror:2 row_mask:0xf bank_mask:0xf
    s_nop 1
    v_add_f32_dpp v96, v96, v96 row_ror:1 row_mask:0xf bank_mask:0xf
    s_nop 1
    v_add_f32_dpp v96, v96, v96 row_bcast:15 row_mask:0xa bank_mask:0xf
    s_nop 0
    v_readlane_b32 s62, v96, 31
    v_readlane_b32 s63, v96, 63
    s_nop 0
    v_mul_f32 v96, s62, v104
    v_fma_f32 v98, s63, v104, v105
    v_fma_f32 v98, -v96, v96, v98
    v_max_f32 v98, v105, v98
    v_rsq_f32 v98, v98
    s_nop 0
    v_mul_f32_e64 v96, v96, -v98
    v_pk_fma_f32 v[32:33], v[16:17], v[98:99], v[96:97] op_sel_hi:[1,0,0]
    v_pk_fma_f32 v[34:35], v[18:19], v[98:99], v[96:97] op_sel_hi:[1,0,0]
    v_pk_fma_f32 v[36:37], v[20:21], v[98:99], v[96:97] op_sel_hi:[1,0,0]
    v_pk_fma_f32 v[38:39], v[22:23], v[98:99], v[96:97] op_sel_hi:[1,0,0]
    s_branch L_loop
L_mssm:
    s_waitcnt vmcnt(3)
    s_lshl_b32 s62, s14, 16
    v_lshlrev_b32 v56, 16, v100
    v_add_f32 v56, s62, v56
    v_cvt_pk_bf16_f32 v56, v56, v56
    v_mov_b32 v57, 0xffff
    v_bfi_b32 v56, v57, v56, v100
    v_cmp_eq_u32 vcc, 0, v0
    s_nop 1
    v_cndmask_b32 v100, v100, v56, vcc
    s_cmp_eq_u32 s3, 0
    s_cbranch_scc0 Lbz_7
    v_lshrrev_b32 v64, 1, v1
    v_mul_u32_u24 v64, 4160, v64
    v_and_b32 v65, 1, v1
    v_lshl_add_u32 v64, v65, 4, v64
    v_lshlrev_b32 v65, 4, v1
    v_sub_u32 v65, v112, v65
    v_add_u32 v64, v64, v65
    v_mov_b32 v68, 0
    v_mov_b32 v69, 0
    v_mov_b32 v70, 0
    v_mov_b32 v71, 0
    v_alignbit_b32 v65, v101, v100, 16
    v_lshlrev_b32 v66, 16, v100
    s_mov_b64 exec, 0xff
    ds_write_b128 v64, v[68:71] offset:0
    s_mov_b64 exec, 1
    ds_write_b32 v112, v66 offset:4188
    ds_write_b32 v112, v100 offset:8348
    ds_write_b32 v112, v66 offset:12504
    ds_write_b32 v112, v65 offset:12508
    s_mov_b64 exec, -1
Lbz_7:
    ds_write_b128 v112, v[100:103] offset:32
    v_alignbit_b32 v64, v101, v100, 16
    v_alignbit_b32 v65, v102, v101, 16
    v_alignbit_b32 v66, v103, v102, 16
    v_alignbit_b32 v67, v104, v103, 16
    ds_write_b128 v112, v[64:67] offset:4192
    v_mov_b32 v68, v101
    v_mov_b32 v69, v102
    v_mov_b32 v70, v103
    v_mov_b32 v71, v104
    ds_write_b128 v112, v[68:71] offset:8352
    v_mov_b32 v72, v65
    v_mov_b32 v73, v66
    v_mov_b32 v74, v67
    v_alignbit_b32 v75, v105, v104, 16
    ds_write_b128 v112, v[72:75] offset:12512
    s_and_b32 s62, s14, 0xffff0000
    v_lshlrev_b32 v56, 16, v106
    v_add_f32 v56, s62, v56
    v_cvt_pk_bf16_f32 v56, v56, v56
    v_mov_b32 v57, 0xffff
    v_bfi_b32 v56, v57, v56, v106
    v_cmp_eq_u32 vcc, 0, v0
    s_nop 1
    v_cndmask_b32 v106, v106, v56, vcc
    s_cmp_eq_u32 s3, 0
    s_cbranch_scc0 Lbz_8
    v_lshrrev_b32 v76, 1, v1
    v_mul_u32_u24 v76, 4160, v76
    v_and_b32 v77, 1, v1
    v_lshl_add_u32 v76, v77, 4, v76
    v_lshlrev_b32 v77, 4, v1
    v_sub_u32 v77, v112, v77
    v_add_u32 v76, v76, v77
    v_mov_b32 v80, 0
    v_mov_b32 v81, 0
    v_mov_b32 v82, 0
    v_mov_b32 v83, 0
    v_alignbit_b32 v77, v107, v106, 16
    v_lshlrev_b32 v78, 16, v106
    s_mov_b64 exec, 0xff
    ds_write_b128 v76, v[80:83] offset:16640
    s_mov_b64 exec, 1
    ds_write_b32 v112, v78 offset:20828
    ds_write_b32 v112, v106 offset:24988
    ds_write_b32 v112, v78 offset:29144
    ds_write_b32 v112, v77 offset:29148
    s_mov_b64 exec, -1
Lbz_8:
    ds_write_b128 v112, v[106:109] offset:16672
    v_alignbit_b32 v76, v107, v106, 16
    v_alignbit_b32 v77, v108, v107, 16
    v_alignbit_b32 v78, v109, v108, 16
    v_alignbit_b32 v79, v110, v109, 16
    ds_write_b128 v112, v[76:79] offset:20832
    v_mov_b32 v80, v107
    v_mov_b32 v81, v108
    v_mov_b32 v82, v109
    v_mov_b32 v83, v110
    ds_write_b128 v112, v[80:83] offset:24992
    v_mov_b32 v84, v77
    v_mov_b32 v85, v78
    v_mov_b32 v86, v79
    v_alignbit_b32 v87, v111, v110, 16
    ds_write_b128 v112, v[84:87] offset:29152
    s_mov_b64 exec, 1
    ds_add_u32 v15, v14 offset:64
    s_mov_b64 exec, -1
Ls_9:
    ds_read_b32 v41, v15 offset:64
    s_waitcnt lgkmcnt(0)
    v_cmp_le_u32 vcc, 4, v41
    s_cbranch_vccnz Lsd_10
    s_sub_u32 s12, s12, 1
    s_cbranch_scc1 L_exit
    s_branch Ls_9
Lsd_10:
    ds_read_b64 v[128:129], v10 offset:0
    ds_read_b64 v[130:131], v10 offset:8
    ds_read_b64 v[160:161], v10 offset:64
    ds_read_b64 v[162:163], v10 offset:72
    ds_read_b64 v[192:193], v10 offset:128
    ds_read_b64 v[194:195], v10 offset:136
    ds_read_b64 v[224:225], v10 offset:192
    ds_read_b64 v[226:227], v10 offset:200
    ds_read_b64 v[132:133], v10 offset:512
    ds_read_b64 v[134:135], v10 offset:520
    ds_read_b64 v[164:165], v10 offset:576
    ds_read_b64 v[166:167], v10 offset:584
    ds_read_b64 v[196:197], v10 offset:640
    ds_read_b64 v[198:199], v10 offset:648
    ds_read_b64 v[228:229], v10 offset:704
    ds_read_b64 v[230:231], v10 offset:712
    ds_read_b64 v[136:137], v10 offset:1024
    ds_read_b64 v[138:139], v10 offset:1032
    ds_read_b64 v[168:169], v10 offset:1088
    ds_read_b64 v[170:171], v10 offset:1096
    ds_read_b64 v[200:201], v10 offset:1152
    ds_read_b64 v[202:203], v10 offset:1160
    ds_read_b64 v[232:233], v10 offset:1216
    ds_read_b64 v[234:235], v10 offset:1224
    ds_read_b64 v[140:141], v10 offset:1536
    ds_read_b64 v[142:143], v10 offset:1544
    ds_read_b64 v[172:173], v10 offset:1600
    ds_read_b64 v[174:175], v10 offset:1608
    ds_read_b64 v[204:205], v10 offset:1664
    ds_read_b64 v[206:207], v10 offset:1672
    ds_read_b64 v[236:237], v10 offset:1728
    ds_read_b64 v[238:239], v10 offset:1736
    ds_read_b64 v[144:145], v10 offset:2048
    ds_read_b64 v[146:147], v10 offset:2056
    ds_read_b64 v[176:177], v10 offset:2112
    ds_read_b64 v[178:179], v10 offset:2120
    ds_read_b64 v[208:209], v10 offset:2176
    ds_read_b64 v[210:211], v10 offset:2184
    ds_read_b64 v[240:241], v10 offset:2240
    ds_read_b64 v[242:243], v10 offset:2248
    ds_read_b64 v[148:149], v10 offset:2560
    ds_read_b64 v[150:151], v10 offset:2568
    ds_read_b64 v[180:181], v10 offset:2624
    ds_read_b64 v[182:183], v10 offset:2632
    ds_read_b64 v[212:213], v10 offset:2688
    ds_read_b64 v[214:215], v10 offset:2696
    ds_read_b64 v[244:245], v10 offset:2752
    ds_read_b64 v[246:247], v10 offset:2760
    ds_read_b64 v[152:153], v10 offset:3072
    ds_read_b64 v[154:155], v10 offset:3080
    ds_read_b64 v[184:185], v10 offset:3136
    ds_read_b64 v[186:187], v10 offset:3144
    ds_read_b64 v[216:217], v10 offset:3200
    ds_read_b64 v[218:219], v10 offset:3208
    ds_read_b64 v[248:249], v10 offset:3264
    ds_read_b64 v[250:251], v10 offset:3272
    ds_read_b64 v[156:157], v10 offset:3584
    ds_read_b64 v[158:159], v10 offset:3592
    ds_read_b64 v[188:189], v10 offset:3648
    ds_read_b64 v[190:191], v10 offset:3656
    ds_read_b64 v[220:221], v10 offset:3712
    ds_read_b64 v[222:223], v10 offset:3720
    ds_read_b64 v[252:253], v10 offset:3776
    ds_read_b64 v[254:255], v10 offset:3784
    v_add_u32 v10, -93184, v10
    s_waitcnt vmcnt(2)
    v_lshlrev_b32 v16, 16, v24
    v_and_b32 v17, 0xffff0000, v24
    v_lshlrev_b32 v18, 16, v25
    v_and_b32 v19, 0xffff0000, v25
    v_lshlrev_b32 v20, 16, v26
    v_and_b32 v21, 0xffff0000, v26
    v_lshlrev_b32 v22, 16, v27
    v_and_b32 v23, 0xffff0000, v27
    v_mov_b32 v104, 0x3b000000
    v_mov_b32 v105, 0x3727c5ac
    v_pk_add_f32 v[96:97], v[16:17], v[18:19]
    v_pk_mul_f32 v[100:101], v[16:17], v[16:17]
    v_pk_add_f32 v[98:99], v[20:21], v[22:23]
    v_pk_mul_f32 v[102:103], v[20:21], v[20:21]
    v_pk_fma_f32 v[100:101], v[18:19], v[18:19], v[100:101]
    v_pk_fma_f32 v[102:103], v[22:23], v[22:23], v[102:103]
    v_pk_add_f32 v[96:97], v[96:97], v[98:99]
    v_pk_add_f32 v[100:101], v[100:101], v[102:103]
    v_add_f32 v96, v96, v97
    v_add_f32 v100, v100, v101
    s_nop 1
    v_permlane32_swap_b32 v96, v100
    v_add_f32 v96, v96, v100
    s_nop 1
    v_add_f32_dpp v96, v96, v96 row_ror:8 row_mask:0xf bank_mask:0xf
    s_nop 1
    v_add_f32_dpp v96, v96, v96 row_ror:4 row_mask:0xf bank_mask:0xf
    s_nop 1
    v_add_f32_dpp v96, v96, v96 row_ror:2 row_mask:0xf bank_mask:0xf
    s_nop 1
    v_add_f32_dpp v96, v96, v96 row_ror:1 row_mask:0xf bank_mask:0xf
    s_nop 1
    v_add_f32_dpp v96, v96, v96 row_bcast:15 row_mask:0xa bank_mask:0xf
    s_nop 0
    v_readlane_b32 s62, v96, 31
    v_readlane_b32 s63, v96, 63
    s_nop 0
    v_mul_f32 v96, s62, v104
    v_fma_f32 v98, s63, v104, v105
    v_fma_f32 v98, -v96, v96, v98
    v_max_f32 v98, v105, v98
    v_rsq_f32 v98, v98
    s_nop 0
    v_mul_f32_e64 v96, v96, -v98
    v_pk_fma_f32 v[112:113], v[16:17], v[98:99], v[96:97] op_sel_hi:[1,0,0]
    v_pk_fma_f32 v[114:115], v[18:19], v[98:99], v[96:97] op_sel_hi:[1,0,0]
    v_pk_fma_f32 v[116:117], v[20:21], v[98:99], v[96:97] op_sel_hi:[1,0,0]
    v_pk_fma_f32 v[118:119], v[22:23], v[98:99], v[96:97] op_sel_hi:[1,0,0]
    v_cvt_pk_bf16_f32 v28, v112, v113
    v_cvt_pk_bf16_f32 v29, v114, v115
    v_cvt_pk_bf16_f32 v30, v116, v117
    v_cvt_pk_bf16_f32 v31, v118, v119
L_loop:
    v_mov_b32 v62, s13
    s_cmp_ge_u32 s3, 4
    s_cbranch_scc1 L_helper
Ls_11:
    ds_read_b32 v41, v15 offset:72
    s_waitcnt lgkmcnt(0)
    v_cmp_le_u32 vcc, s13, v41
    s_cbranch_vccnz Lsd_12
    s_sleep 2
    s_sub_u32 s12, s12, 1
    s_cbranch_scc1 L_exit
    s_branch Ls_11
Lsd_12:
L_slow0:
    ds_read_b32 v56, v15 offset:0
    ds_read_b128 v[64:67], v8 offset:192
    ds_read_b128 v[68:71], v8 offset:128
    ds_read_b128 v[72:75], v8 offset:64
    ds_read_b128 v[76:79], v8 offset:0
    s_waitcnt lgkmcnt(0)
    v_mov_b32 v57, 0
    v_cmp_eq_u32 vcc, v62, v56
    s_cbranch_vccnz L_back0
    s_sub_u32 s12, s12, 1
    s_cbranch_scc1 L_exit
    s_branch L_slow0
L_back0:
    v_mfma_f32_16x16x32_bf16 v[96:99], v[128:131], v[64:67], 0
    v_mfma_f32_16x16x32_bf16 v[96:99], v[160:163], v[68:71], v[96:99]
    v_mfma_f32_16x16x32_bf16 v[96:99], v[192:195], v[72:75], v[96:99]
    v_mfma_f32_16x16x32_bf16 v[96:99], v[224:227], v[76:79], v[96:99]
    v_mfma_f32_16x16x32_bf16 v[100:103], v[132:135], v[64:67], 0
    v_mfma_f32_16x16x32_bf16 v[104:107], v[136:139], v[64:67], 0
    v_mfma_f32_16x16x32_bf16 v[108:111], v[140:143], v[64:67], 0
    v_mfma_f32_16x16x32_bf16 v[112:115], v[144:147], v[64:67], 0
    v_mfma_f32_16x16x32_bf16 v[116:119], v[148:151], v[64:67], 0
    s_nop 2
    ds_write_b128 v9, v[96:99] offset:0
    v_mfma_f32_16x16x32_bf16 v[120:123], v[152:155], v[64:67], 0
    ds_write_b32 v11, v62 offset:0
    v_mfma_f32_16x16x32_bf16 v[124:127], v[156:159], v[64:67], 0
    v_mfma_f32_16x16x32_bf16 v[100:103], v[164:167], v[68:71], v[100:103]
    v_mfma_f32_16x16x32_bf16 v[104:107], v[168:171], v[68:71], v[104:107]
    v_mfma_f32_16x16x32_bf16 v[108:111], v[172:175], v[68:71], v[108:111]
    v_mfma_f32_16x16x32_bf16 v[112:115], v[176:179], v[68:71], v[112:115]
    v_mfma_f32_16x16x32_bf16 v[116:119], v[180:183], v[68:71], v[116:119]
    v_mfma_f32_16x16x32_bf16 v[120:123], v[184:187], v[68:71], v[120:123]
    v_mfma_f32_16x16x32_bf16 v[124:127], v[188:191], v[68:71], v[124:127]
    v_mfma_f32_16x16x32_bf16 v[100:103], v[196:199], v[72:75], v[100:103]
    v_mfma_f32_16x16x32_bf16 v[104:107], v[200:203], v[72:75], v[104:107]
    v_mfma_f32_16x16x32_bf16 v[108:111], v[204:207], v[72:75], v[108:111]
    v_mfma_f32_16x16x32_bf16 v[112:115], v[208:211], v[72:75], v[112:115]
    ds_read_b32 v57, v15 offset:4
    v_mfma_f32_16x16x32_bf16 v[116:119], v[212:215], v[72:75], v[116:119]
    ds_read_b128 v[80:83], v8 offset:704
    v_mfma_f32_16x16x32_bf16 v[120:123], v[216:219], v[72:75], v[120:123]
    ds_read_b128 v[84:87], v8 offset:640
    v_mfma_f32_16x16x32_bf16 v[124:127], v[220:223], v[72:75], v[124:127]
    ds_read_b128 v[88:91], v8 offset:576
    v_mfma_f32_16x16x32_bf16 v[100:103], v[228:231], v[76:79], v[100:103]
    ds_read_b128 v[92:95], v8 offset:512
    v_mfma_f32_16x16x32_bf16 v[104:107], v[232:235], v[76:79], v[104:107]
    v_mfma_f32_16x16x32_bf16 v[108:111], v[236:239], v[76:79], v[108:111]
    v_mfma_f32_16x16x32_bf16 v[112:115], v[240:243], v[76:79], v[112:115]
    v_mfma_f32_16x16x32_bf16 v[116:119], v[244:247], v[76:79], v[116:119]
    v_mfma_f32_16x16x32_bf16 v[120:123], v[248:251], v[76:79], v[120:123]
    s_waitcnt lgkmcnt(0)
    v_cmp_eq_u32 vcc, v62, v57
    v_mfma_f32_16x16x32_bf16 v[124:127], v[252:255], v[76:79], v[124:127]
    s_cbranch_vccz L_slow1
L_back1:
    v_mfma_f32_16x16x32_bf16 v[100:103], v[128:131], v[80:83], v[100:103]
    v_mfma_f32_16x16x32_bf16 v[100:103], v[160:163], v[84:87], v[100:103]
    v_mfma_f32_16x16x32_bf16 v[100:103], v[192:195], v[88:91], v[100:103]
    v_mfma_f32_16x16x32_bf16 v[100:103], v[224:227], v[92:95], v[100:103]
    v_mfma_f32_16x16x32_bf16 v[104:107], v[132:135], v[80:83], v[104:107]
    v_mfma_f32_16x16x32_bf16 v[108:111], v[136:139], v[80:83], v[108:111]
    v_mfma_f32_16x16x32_bf16 v[112:115], v[140:143], v[80:83], v[112:115]
    v_mfma_f32_16x16x32_bf16 v[116:119], v[144:147], v[80:83], v[116:119]
    v_mfma_f32_16x16x32_bf16 v[120:123], v[148:151], v[80:83], v[120:123]
    s_nop 2
    ds_write_b128 v9, v[100:103] offset:4096
    v_mfma_f32_16x16x32_bf16 v[124:127], v[152:155], v[80:83], v[124:127]
    ds_write_b32 v11, v62 offset:16
    v_mfma_f32_16x16x32_bf16 v[104:107], v[164:167], v[84:87], v[104:107]
    v_mfma_f32_16x16x32_bf16 v[108:111], v[168:171], v[84:87], v[108:111]
    v_mfma_f32_16x16x32_bf16 v[112:115], v[172:175], v[84:87], v[112:115]
    v_mfma_f32_16x16x32_bf16 v[116:119], v[176:179], v[84:87], v[116:119]
    v_mfma_f32_16x16x32_bf16 v[120:123], v[180:183], v[84:87], v[120:123]
    v_mfma_f32_16x16x32_bf16 v[124:127], v[184:187], v[84:87], v[124:127]
    v_mfma_f32_16x16x32_bf16 v[104:107], v[196:199], v[88:91], v[104:107]
    v_mfma_f32_16x16x32_bf16 v[108:111], v[200:203], v[88:91], v[108:111]
    ds_read_b32 v56, v15 offset:8
    v_mfma_f32_16x16x32_bf16 v[112:115], v[204:207], v[88:91], v[112:115]
    ds_read_b128 v[32:35], v8 offset:1216
    v_mfma_f32_16x16x32_bf16 v[116:119], v[208:211], v[88:91], v[116:119]
    ds_read_b128 v[36:39], v8 offset:1152
    v_mfma_f32_16x16x32_bf16 v[120:123], v[212:215], v[88:91], v[120:123]
    ds_read_b128 v[40:43], v8 offset:1088
    v_mfma_f32_16x16x32_bf16 v[124:127], v[216:219], v[88:91], v[124:127]
    ds_read_b128 v[44:47], v8 offset:1024
    v_mfma_f32_16x16x32_bf16 v[104:107], v[228:231], v[92:95], v[104:107]
    v_mfma_f32_16x16x32_bf16 v[108:111], v[232:235], v[92:95], v[108:111]
    v_mfma_f32_16x16x32_bf16 v[112:115], v[236:239], v[92:95], v[112:115]
    v_mfma_f32_16x16x32_bf16 v[116:119], v[240:243], v[92:95], v[116:119]
    v_mfma_f32_16x16x32_bf16 v[120:123], v[244:247], v[92:95], v[120:123]
    s_waitcnt lgkmcnt(0)
    v_cmp_eq_u32 vcc, v62, v56
    v_mfma_f32_16x16x32_bf16 v[124:127], v[248:251], v[92:95], v[124:127]
    s_cbranch_vccz L_slow2
L_back2:
    v_mfma_f32_16x16x32_bf16 v[104:107], v[128:131], v[32:35], v[104:107]
    v_mfma_f32_16x16x32_bf16 v[104:107], v[160:163], v[36:39], v[104:107]
    v_mfma_f32_16x16x32_bf16 v[104:107], v[192:195], v[40:43], v[104:107]
    v_mfma_f32_16x16x32_bf16 v[104:107], v[224:227], v[44:47], v[104:107]
    v_mfma_f32_16x16x32_bf16 v[108:111], v[132:135], v[32:35], v[108:111]
    v_mfma_f32_16x16x32_bf16 v[112:115], v[136:139], v[32:35], v[112:115]
    v_mfma_f32_16x16x32_bf16 v[116:119], v[140:143], v[32:35], v[116:119]
    v_mfma_f32_16x16x32_bf16 v[120:123], v[144:147], v[32:35], v[120:123]
    v_mfma_f32_16x16x32_bf16 v[124:127], v[148:151], v[32:35], v[124:127]
    s_nop 2
    ds_write_b128 v9, v[104:107] offset:8192
    v_mfma_f32_16x16x32_bf16 v[108:111], v[164:167], v[36:39], v[108:111]
    ds_write_b32 v11, v62 offset:32
    v_mfma_f32_16x16x32_bf16 v[112:115], v[168:171], v[36:39], v[112:115]
    v_mfma_f32_16x16x32_bf16 v[116:119], v[172:175], v[36:39], v[116:119]
    v_mfma_f32_16x16x32_bf16 v[120:123], v[176:179], v[36:39], v[120:123]
    v_mfma_f32_16x16x32_bf16 v[124:127], v[180:183], v[36:39], v[124:127]
    ds_read_b32 v57, v15 offset:12
    v_mfma_f32_16x16x32_bf16 v[108:111], v[196:199], v[40:43], v[108:111]
    ds_read_b128 v[64:67], v8 offset:1728
    v_mfma_f32_16x16x32_bf16 v[112:115], v[200:203], v[40:43], v[112:115]
    ds_read_b128 v[68:71], v8 offset:1664
    v_mfma_f32_16x16x32_bf16 v[116:119], v[204:207], v[40:43], v[116:119]
    ds_read_b128 v[72:75], v8 offset:1600
    v_mfma_f32_16x16x32_bf16 v[120:123], v[208:211], v[40:43], v[120:123]
    ds_read_b128 v[76:79], v8 offset:1536
    v_mfma_f32_16x16x32_bf16 v[124:127], v[212:215], v[40:43], v[124:127]
    v_mfma_f32_16x16x32_bf16 v[108:111], v[228:231], v[44:47], v[108:111]
    v_mfma_f32_16x16x32_bf16 v[112:115], v[232:235], v[44:47], v[112:115]
    v_mfma_f32_16x16x32_bf16 v[116:119], v[236:239], v[44:47], v[116:119]
    v_mfma_f32_16x16x32_bf16 v[120:123], v[240:243], v[44:47], v[120:123]
    s_waitcnt lgkmcnt(0)
    v_cmp_eq_u32 vcc, v62, v57
    v_mfma_f32_16x16x32_bf16 v[124:127], v[244:247], v[44:47], v[124:127]
    s_cbranch_vccz L_slow3
L_back3:
    v_mfma_f32_16x16x32_bf16 v[108:111], v[128:131], v[64:67], v[108:111]
    v_mfma_f32_16x16x32_bf16 v[108:111], v[160:163], v[68:71], v[108:111]
    v_mfma_f32_16x16x32_bf16 v[108:111], v[192:195], v[72:75], v[108:111]
    v_mfma_f32_16x16x32_bf16 v[108:111], v[224:227], v[76:79], v[108:111]
    v_mfma_f32_16x16x32_bf16 v[112:115], v[132:135], v[64:67], v[112:115]
    v_mfma_f32_16x16x32_bf16 v[116:119], v[136:139], v[64:67], v[116:119]
    v_mfma_f32_16x16x32_bf16 v[120:123], v[140:143], v[64:67], v[120:123]
    v_mfma_f32_16x16x32_bf16 v[124:127], v[144:147], v[64:67], v[124:127]
    v_mfma_f32_16x16x32_bf16 v[112:115], v[164:167], v[68:71], v[112:115]
    s_nop 2
    ds_write_b128 v9, v[108:111] offset:12288
    v_mfma_f32_16x16x32_bf16 v[116:119], v[168:171], v[68:71], v[116:119]
    ds_write_b32 v11, v62 offset:48
    v_mfma_f32_16x16x32_bf16 v[120:123], v[172:175], v[68:71], v[120:123]
    ds_read_b32 v56, v15 offset:16
    v_mfma_f32_16x16x32_bf16 v[124:127], v[176:179], v[68:71], v[124:127]
    ds_read_b128 v[80:83], v8 offset:2240
    v_mfma_f32_16x16x32_bf16 v[112:115], v[196:199], v[72:75], v[112:115]
    ds_read_b128 v[84:87], v8 offset:2176
    v_mfma_f32_16x16x32_bf16 v[116:119], v[200:203], v[72:75], v[116:119]
    ds_read_b128 v[88:91], v8 offset:2112
    v_mfma_f32_16x16x32_bf16 v[120:123], v[204:207], v[72:75], v[120:123]
    ds_read_b128 v[92:95], v8 offset:2048
    v_mfma_f32_16x16x32_bf16 v[124:127], v[208:211], v[72:75], v[124:127]
    v_mfma_f32_16x16x32_bf16 v[112:115], v[228:231], v[76:79], v[112:115]
    v_mfma_f32_16x16x32_bf16 v[116:119], v[232:235], v[76:79], v[116:119]
    v_mfma_f32_16x16x32_bf16 v[120:123], v[236:239], v[76:79], v[120:123]
    s_waitcnt lgkmcnt(0)
    v_cmp_eq_u32 vcc, v62, v56
    v_mfma_f32_16x16x32_bf16 v[124:127], v[240:243], v[76:79], v[124:127]
    s_cbranch_vccz L_slow4
L_back4:
    v_mfma_f32_16x16x32_bf16 v[112:115], v[128:131], v[80:83], v[112:115]
    v_mfma_f32_16x16x32_bf16 v[112:115], v[160:163], v[84:87], v[112:115]
    v_mfma_f32_16x16x32_bf16 v[112:115], v[192:195], v[88:91], v[112:115]
    v_mfma_f32_16x16x32_bf16 v[112:115], v[224:227], v[92:95], v[112:115]
    v_mfma_f32_16x16x32_bf16 v[116:119], v[132:135], v[80:83], v[116:119]
    v_mfma_f32_16x16x32_bf16 v[120:123], v[136:139], v[80:83], v[120:123]
    ds_read_b32 v57, v15 offset:20
    v_mfma_f32_16x16x32_bf16 v[124:127], v[140:143], v[80:83], v[124:127]
    ds_read_b128 v[32:35], v8 offset:2752
    v_mfma_f32_16x16x32_bf16 v[116:119], v[164:167], v[84:87], v[116:119]
    ds_read_b128 v[36:39], v8 offset:2688
    v_mfma_f32_16x16x32_bf16 v[120:123], v[168:171], v[84:87], v[120:123]
    ds_write_b128 v9, v[112:115] offset:16384
    v_mfma_f32_16x16x32_bf16 v[124:127], v[172:175], v[84:87], v[124:127]
    ds_write_b32 v11, v62 offset:64
    v_mfma_f32_16x16x32_bf16 v[116:119], v[196:199], v[88:91], v[116:119]
    ds_read_b128 v[40:43], v8 offset:2624
    v_mfma_f32_16x16x32_bf16 v[120:123], v[200:203], v[88:91], v[120:123]
    ds_read_b128 v[44:47], v8 offset:2560
    v_mfma_f32_16x16x32_bf16 v[124:127], v[204:207], v[88:91], v[124:127]
    v_mfma_f32_16x16x32_bf16 v[116:119], v[228:231], v[92:95], v[116:119]
    v_mfma_f32_16x16x32_bf16 v[120:123], v[232:235], v[92:95], v[120:123]
    s_waitcnt lgkmcnt(0)
    v_cmp_eq_u32 vcc, v62, v57
    v_mfma_f32_16x16x32_bf16 v[124:127], v[236:239], v[92:95], v[124:127]
    s_cbranch_vccz L_slow5
L_back5:
    v_mfma_f32_16x16x32_bf16 v[116:119], v[128:131], v[32:35], v[116:119]
    v_mfma_f32_16x16x32_bf16 v[116:119], v[160:163], v[36:39], v[116:119]
    ds_read_b32 v56, v15 offset:24
    v_mfma_f32_16x16x32_bf16 v[116:119], v[192:195], v[40:43], v[116:119]
    ds_read_b128 v[64:67], v8 offset:3264
    v_mfma_f32_16x16x32_bf16 v[116:119], v[224:227], v[44:47], v[116:119]
    ds_read_b128 v[68:71], v8 offset:3200
    v_mfma_f32_16x16x32_bf16 v[120:123], v[132:135], v[32:35], v[120:123]
    ds_read_b128 v[72:75], v8 offset:3136
    v_mfma_f32_16x16x32_bf16 v[124:127], v[136:139], v[32:35], v[124:127]
    ds_read_b128 v[76:79], v8 offset:3072
    v_mfma_f32_16x16x32_bf16 v[120:123], v[164:167], v[36:39], v[120:123]
    v_mfma_f32_16x16x32_bf16 v[124:127], v[168:171], v[36:39], v[124:127]
    v_mfma_f32_16x16x32_bf16 v[120:123], v[196:199], v[40:43], v[120:123]
    ds_write_b128 v9, v[116:119] offset:20480
    v_mfma_f32_16x16x32_bf16 v[124:127], v[200:203], v[40:43], v[124:127]
    ds_write_b32 v11, v62 offset:80
    v_mfma_f32_16x16x32_bf16 v[120:123], v[228:231], v[44:47], v[120:123]
    ds_read_b32 v57, v15 offset:28
    s_waitcnt lgkmcnt(3)
    v_cmp_eq_u32 vcc, v62, v56
    v_mfma_f32_16x16x32_bf16 v[124:127], v[232:235], v[44:47], v[124:127]
    ds_read_b128 v[80:83], v8 offset:3776
    s_cbranch_vccz L_slow6
L_back6:
    v_mfma_f32_16x16x32_bf16 v[120:123], v[128:131], v[64:67], v[120:123]
    ds_read_b128 v[84:87], v8 offset:3712
    v_mfma_f32_16x16x32_bf16 v[120:123], v[160:163], v[68:71], v[120:123]
    ds_read_b128 v[88:91], v8 offset:3648
    v_mfma_f32_16x16x32_bf16 v[120:123], v[192:195], v[72:75], v[120:123]
    ds_read_b128 v[92:95], v8 offset:3584
    v_mfma_f32_16x16x32_bf16 v[120:123], v[224:227], v[76:79], v[120:123]
    v_mfma_f32_16x16x32_bf16 v[124:127], v[132:135], v[64:67], v[124:127]
    v_mfma_f32_16x16x32_bf16 v[124:127], v[164:167], v[68:71], v[124:127]
    v_mfma_f32_16x16x32_bf16 v[124:127], v[196:199], v[72:75], v[124:127]
    s_waitcnt lgkmcnt(0)
    v_cmp_eq_u32 vcc, v62, v57
    v_mfma_f32_16x16x32_bf16 v[124:127], v[228:231], v[76:79], v[124:127]
    s_cbranch_vccz L_slow7
L_back7:
    v_mfma_f32_16x16x32_bf16 v[124:127], v[128:131], v[80:83], v[124:127]
    ds_write_b128 v9, v[120:123] offset:24576
    v_mfma_f32_16x16x32_bf16 v[124:127], v[160:163], v[84:87], v[124:127]
    ds_write_b32 v11, v62 offset:96
    v_mfma_f32_16x16x32_bf16 v[124:127], v[192:195], v[88:91], v[124:127]
    v_mfma_f32_16x16x32_bf16 v[124:127], v[224:227], v[92:95], v[124:127]
    s_nop 7
    ds_write_b128 v9, v[124:127] offset:28672
    ds_write_b32 v11, v62 offset:112
L_post:
L_post2:
    s_cmp_eq_u32 s13, 1
    s_cbranch_scc0 L_mr
    s_cmp_ge_u32 s3, 6
    s_cbranch_scc1 L_x8
    s_waitcnt vmcnt(0)
L_x8:
    s_cmp_ge_u32 s3, 6
    s_cbranch_scc1 L_mr
    s_cmp_ge_u32 s3, 4
    s_cbranch_scc1 L_l4
    v_lshlrev_b32 v32, 16, v28
    v_and_b32 v33, 0xffff0000, v28
    v_lshlrev_b32 v34, 16, v29
    v_and_b32 v35, 0xffff0000, v29
    v_lshlrev_b32 v36, 16, v30
    v_and_b32 v37, 0xffff0000, v30
    v_lshlrev_b32 v38, 16, v31
    v_and_b32 v39, 0xffff0000, v31
    s_branch L_mr
L_l4:
    v_lshlrev_b32 v16, 16, v24
    v_and_b32 v17, 0xffff0000, v24
    v_lshlrev_b32 v18, 16, v25
    v_and_b32 v19, 0xffff0000, v25
    v_lshlrev_b32 v20, 16, v26
    v_and_b32 v21, 0xffff0000, v26
    v_lshlrev_b32 v22, 16, v27
    v_and_b32 v23, 0xffff0000, v27
    v_mov_b32 v120, 0x3b000000
    v_mov_b32 v121, 0x3727c5ac
    v_pk_add_f32 v[112:113], v[16:17], v[18:19]
    v_pk_mul_f32 v[116:117], v[16:17], v[16:17]
    v_pk_add_f32 v[114:115], v[20:21], v[22:23]
    v_pk_mul_f32 v[118:119], v[20:21], v[20:21]
    v_pk_fma_f32 v[116:117], v[18:19], v[18:19], v[116:117]
    v_pk_fma_f32 v[118:119], v[22:23], v[22:23], v[118:119]
    v_pk_add_f32 v[112:113], v[112:113], v[114:115]
    v_pk_add_f32 v[116:117], v[116:117], v[118:119]
    v_add_f32 v112, v112, v113
    v_add_f32 v116, v116, v117
    s_nop 1
    v_permlane32_swap_b32 v112, v116
    v_add_f32 v112, v112, v116
    s_nop 1
    v_add_f32_dpp v112, v112, v112 row_ror:8 row_mask:0xf bank_mask:0xf
    s_nop 1
    v_add_f32_dpp v112, v112, v112 row_ror:4 row_mask:0xf bank_mask:0xf
    s_nop 1
    v_add_f32_dpp v112, v112, v112 row_ror:2 row_mask:0xf bank_mask:0xf
    s_nop 1
    v_add_f32_dpp v112, v112, v112 row_ror:1 row_mask:0xf bank_mask:0xf
    s_nop 1
    v_add_f32_dpp v112, v112, v112 row_bcast:15 row_mask:0xa bank_mask:0xf
    s_nop 0
    v_readlane_b32 s62, v112, 31
    v_readlane_b32 s63, v112, 63
    s_nop 0
    v_mul_f32 v112, s62, v120
    v_fma_f32 v114, s63, v120, v121
    v_fma_f32 v114, -v112, v112, v114
    v_max_f32 v114, v121, v114
    v_rsq_f32 v114, v114
    s_nop 0
    v_mul_f32_e64 v112, v112, -v114
    v_pk_fma_f32 v[32:33], v[16:17], v[114:115], v[112:113] op_sel_hi:[1,0,0]
    v_pk_fma_f32 v[34:35], v[18:19], v[114:115], v[112:113] op_sel_hi:[1,0,0]
    v_pk_fma_f32 v[36:37], v[20:21], v[114:115], v[112:113] op_sel_hi:[1,0,0]
    v_pk_fma_f32 v[38:39], v[22:23], v[114:115], v[112:113] op_sel_hi:[1,0,0]
L_mr:
    s_cmp_ge_u32 s3, 6
    s_cbranch_scc1 L_row
    s_lshl_b32 s56, s10, 2
    v_add_u32 v42, s56, v15
Ls_13:
    ds_read_b32 v41, v42 offset:96
    s_waitcnt lgkmcnt(0)
    v_cmp_le_u32 vcc, s13, v41
    s_cbranch_vccnz Lsd_14
    s_sub_u32 s12, s12, 1
    s_cbranch_scc1 L_exit
    s_branch Ls_13
Lsd_14:
    s_mov_b32 s56, s68
Lb_15:
    s_sub_u32 s56, s56, 1
    s_cbranch_scc1 Lbd_16
    s_sleep 1
    s_branch Lb_15
Lbd_16:
    s_cmp_ge_u32 s3, 4
    s_cbranch_scc0 L_r1
    global_load_dwordx4 v[52:55], v13, s[52:53] sc1
    global_load_dwordx4 v[48:51], v2, s[52:53] sc1
    s_waitcnt vmcnt(1)
    v_max3_u32 v41, v52, v53, v54
    v_max_u32 v41, v41, v55
    v_cmp_eq_u32 vcc, -1, v41
    s_cbranch_vccz Lro_17
Lrr_18:
    s_mov_b64 exec, vcc
    global_load_dwordx4 v[52:55], v13, s[52:53] sc1
    s_waitcnt vmcnt(0)
    v_max3_u32 v41, v52, v53, v54
    v_max_u32 v41, v41, v55
    v_cmp_eq_u32 vcc, -1, v41
    s_cbranch_vccz Lrz_19
    s_sub_u32 s12, s12, 1
    s_cbranch_scc1 L_exit
    s_branch Lrr_18
Lrz_19:
    s_mov_b64 exec, -1
Lro_17:
    ds_write2st64_b32 v61, v52, v53 offset0:1 offset1:5
    ds_write2st64_b32 v61, v54, v55 offset0:9 offset1:13
    s_branch L_r2
L_r1:
    global_load_dwordx4 v[48:51], v2, s[52:53] sc1
L_r2:
    s_waitcnt vmcnt(0)
    v_max3_u32 v41, v48, v49, v50
    v_max_u32 v41, v41, v51
    v_cmp_eq_u32 vcc, -1, v41
    s_cbranch_vccz Lro_20
Lrr_21:
    s_mov_b64 exec, vcc
    global_load_dwordx4 v[48:51], v2, s[52:53] sc1
    s_waitcnt vmcnt(0)
    v_max3_u32 v41, v48, v49, v50
    v_max_u32 v41, v41, v51
    v_cmp_eq_u32 vcc, -1, v41
    s_cbranch_vccz Lrz_22
    s_sub_u32 s12, s12, 1
    s_cbranch_scc1 L_exit
    s_branch Lrr_21
Lrz_22:
    s_mov_b64 exec, -1
Lro_20:
    ds_write2st64_b32 v61, v48, v49 offset0:0 offset1:4
    ds_write2st64_b32 v61, v50, v51 offset0:8 offset1:12
    s_branch L_row
L_slow1:
    ds_read_b32 v57, v15 offset:4
    ds_read_b128 v[80:83], v8 offset:704
    ds_read_b128 v[84:87], v8 offset:640
    ds_read_b128 v[88:91], v8 offset:576
    ds_read_b128 v[92:95], v8 offset:512
    s_waitcnt lgkmcnt(0)
    v_mov_b32 v56, 0
    v_cmp_eq_u32 vcc, v62, v57
    s_cbranch_vccnz L_back1
    s_sub_u32 s12, s12, 1
    s_cbranch_scc1 L_exit
    s_branch L_slow1
L_slow2:
    ds_read_b32 v56, v15 offset:8
    ds_read_b128 v[32:35], v8 offset:1216
    ds_read_b128 v[36:39], v8 offset:1152
    ds_read_b128 v[40:43], v8 offset:1088
    ds_read_b128 v[44:47], v8 offset:1024
    s_waitcnt lgkmcnt(0)
    v_mov_b32 v57, 0
    v_cmp_eq_u32 vcc, v62, v56
    s_cbranch_vccnz L_back2
    s_sub_u32 s12, s12, 1
    s_cbranch_scc1 L_exit
    s_branch L_slow2
L_slow3:
    ds_read_b32 v57, v15 offset:12
    ds_read_b128 v[64:67], v8 offset:1728
    ds_read_b128 v[68:71], v8 offset:1664
    ds_read_b128 v[72:75], v8 offset:1600
    ds_read_b128 v[76:79], v8 offset:1536
    s_waitcnt lgkmcnt(0)
    v_mov_b32 v56, 0
    v_cmp_eq_u32 vcc, v62, v57
    s_cbranch_vccnz L_back3
    s_sub_u32 s12, s12, 1
    s_cbranch_scc1 L_exit
    s_branch L_slow3
L_slow4:
    ds_read_b32 v56, v15 offset:16
    ds_read_b128 v[80:83], v8 offset:2240
    ds_read_b128 v[84:87], v8 offset:2176
    ds_read_b128 v[88:91], v8 offset:2112
    ds_read_b128 v[92:95], v8 offset:2048
    s_waitcnt lgkmcnt(0)
    v_mov_b32 v57, 0
    v_cmp_eq_u32 vcc, v62, v56
    s_cbranch_vccnz L_back4
    s_sub_u32 s12, s12, 1
    s_cbranch_scc1 L_exit
    s_branch L_slow4
L_slow5:
    ds_read_b32 v57, v15 offset:20
    ds_read_b128 v[32:35], v8 offset:2752
    ds_read_b128 v[36:39], v8 offset:2688
    ds_read_b128 v[40:43], v8 offset:2624
    ds_read_b128 v[44:47], v8 offset:2560
    s_waitcnt lgkmcnt(0)
    v_mov_b32 v56, 0
    v_cmp_eq_u32 vcc, v62, v57
    s_cbranch_vccnz L_back5
    s_sub_u32 s12, s12, 1
    s_cbranch_scc1 L_exit
    s_branch L_slow5
L_slow6:
    ds_read_b32 v56, v15 offset:24
    ds_read_b128 v[64:67], v8 offset:3264
    ds_read_b128 v[68:71], v8 offset:3200
    ds_read_b128 v[72:75], v8 offset:3136
    ds_read_b128 v[76:79], v8 offset:3072
    s_waitcnt lgkmcnt(0)
    v_mov_b32 v57, 0
    v_cmp_eq_u32 vcc, v62, v56
    s_cbranch_vccnz L_back6
    s_sub_u32 s12, s12, 1
    s_cbranch_scc1 L_exit
    s_branch L_slow6
L_slow7:
    ds_read_b32 v57, v15 offset:28
    ds_read_b128 v[80:83], v8 offset:3776
    ds_read_b128 v[84:87], v8 offset:3712
    ds_read_b128 v[88:91], v8 offset:3648
    ds_read_b128 v[92:95], v8 offset:3584
    s_waitcnt lgkmcnt(0)
    v_mov_b32 v56, 0
    v_cmp_eq_u32 vcc, v62, v57
    s_cbranch_vccnz L_back7
    s_sub_u32 s12, s12, 1
    s_cbranch_scc1 L_exit
    s_branch L_slow7
L_helper:
    s_cmp_ge_u32 s3, 6
    s_cbranch_scc1 L_fin
    s_cmp_eq_u32 s13, 1
    s_cbranch_scc0 L_g2
    ds_write_b32 v15, v62 offset:72
    s_waitcnt vmcnt(6)
    v_add3_u32 v59, v196, v197, v198
    v_add3_u32 v59, v59, v199, s54
    v_cmp_ne_u32 vcc, v59, v212
    s_cbranch_vccz L_poa0
L_pra0:
    s_mov_b64 exec, vcc
    global_load_dwordx4 v[196:199], v228, s[60:61] sc1
    global_load_dword v212, v232, s[52:53] sc1
    s_waitcnt vmcnt(0)
    v_add3_u32 v59, v196, v197, v198
    v_add3_u32 v59, v59, v199, s54
    v_cmp_ne_u32 vcc, v59, v212
    s_cbranch_vccz L_pza0
    s_sub_u32 s12, s12, 1
    s_cbranch_scc1 L_exit
    s_branch L_pra0
L_pza0:
    s_mov_b64 exec, -1
L_poa0:
    ds_write_b128 v9, v[196:199] offset:0
    ds_write_b32 v12, v62 offset:0
    s_waitcnt vmcnt(4)
    v_add3_u32 v59, v200, v201, v202
    v_add3_u32 v59, v59, v203, s54
    v_cmp_ne_u32 vcc, v59, v213
    s_cbranch_vccz L_poa1
L_pra1:
    s_mov_b64 exec, vcc
    global_load_dwordx4 v[200:203], v229, s[60:61] sc1
    global_load_dword v213, v233, s[52:53] sc1
    s_waitcnt vmcnt(0)
    v_add3_u32 v59, v200, v201, v202
    v_add3_u32 v59, v59, v203, s54
    v_cmp_ne_u32 vcc, v59, v213
    s_cbranch_vccz L_pza1
    s_sub_u32 s12, s12, 1
    s_cbranch_scc1 L_exit
    s_branch L_pra1
L_pza1:
    s_mov_b64 exec, -1
L_poa1:
    ds_write_b128 v9, v[200:203] offset:1024
    ds_write_b32 v12, v62 offset:8
    s_waitcnt vmcnt(2)
    v_add3_u32 v59, v204, v205, v206
    v_add3_u32 v59, v59, v207, s54
    v_cmp_ne_u32 vcc, v59, v214
    s_cbranch_vccz L_poa2
L_pra2:
    s_mov_b64 exec, vcc
    global_load_dwordx4 v[204:207], v230, s[60:61] sc1
    global_load_dword v214, v234, s[52:53] sc1
    s_waitcnt vmcnt(0)
    v_add3_u32 v59, v204, v205, v206
    v_add3_u32 v59, v59, v207, s54
    v_cmp_ne_u32 vcc, v59, v214
    s_cbranch_vccz L_pza2
    s_sub_u32 s12, s12, 1
    s_cbranch_scc1 L_exit
    s_branch L_pra2
L_pza2:
    s_mov_b64 exec, -1
L_poa2:
    ds_write_b128 v9, v[204:207] offset:2048
    ds_write_b32 v12, v62 offset:16
    s_waitcnt vmcnt(0)
    v_add3_u32 v59, v208, v209, v210
    v_add3_u32 v59, v59, v211, s54
    v_cmp_ne_u32 vcc, v59, v215
    s_cbranch_vccz L_poa3
L_pra3:
    s_mov_b64 exec, vcc
    global_load_dwordx4 v[208:211], v231, s[60:61] sc1
    global_load_dword v215, v235, s[52:53] sc1
    s_waitcnt vmcnt(0)
    v_add3_u32 v59, v208, v209, v210
    v_add3_u32 v59, v59, v211, s54
    v_cmp_ne_u32 vcc, v59, v215
    s_cbranch_vccz L_pza3
    s_sub_u32 s12, s12, 1
    s_cbranch_scc1 L_exit
    s_branch L_pra3
L_pza3:
    s_mov_b64 exec, -1
L_poa3:
    ds_write_b128 v9, v[208:211] offset:3072
    ds_write_b32 v12, v62 offset:24
    s_branch L_hk3
L_g2:
    s_cmp_eq_u32 s13, 2
    s_cbranch_scc0 L_g3
    s_sub_u32 s57, s54, 2
Lt_23:
    s_waitcnt vmcnt(0)
    v_xor_b32 v192, s57, v192
    v_xor_b32 v193, s57, v193
    v_xor_b32 v194, s57, v194
    v_xor_b32 v195, s57, v195
    v_or3_b32 v192, v192, v193, v194
    v_or_b32 v192, v192, v195
    v_cmp_ne_u32 vcc, 0, v192
    s_cbranch_vccz Ltd_24
    s_sleep 8
    global_load_dwordx4 v[192:195], v236, s[50:51] sc1
    s_sub_u32 s12, s12, 1
    s_cbranch_scc1 L_exit
    s_branch Lt_23
Ltd_24:
    s_branch L_g4
L_g3:
    s_mov_b32 s69, s55
    s_cmp_lg_u32 s11, 0
    s_cbranch_scc1 L_ge9
L_g4:
    s_mov_b32 s56, s69
Lb_25:
    s_sub_u32 s56, s56, 1
    s_cbranch_scc1 Lbd_26
    s_sleep 1
    s_branch Lb_25
Lbd_26:
    s_cmp_eq_u32 s3, 4
    s_cbranch_scc1 L_g8
    s_sleep 2
L_g8:
    global_load_dwordx4 v[196:199], v228, s[60:61] sc1
L_ge9:
    ds_write_b32 v15, v62 offset:72
    s_waitcnt vmcnt(0)
    v_max3_u32 v59, v196, v197, v198
    v_max_u32 v59, v59, v199
    v_cmp_eq_u32 vcc, -1, v59
    s_cbranch_vccz L_pob0
L_prb0:
    s_mov_b64 exec, vcc
    global_load_dwordx4 v[196:199], v228, s[60:61] sc1
    s_waitcnt vmcnt(0)
    v_max3_u32 v59, v196, v197, v198
    v_max_u32 v59, v59, v199
    v_cmp_eq_u32 vcc, -1, v59
    s_cbranch_vccz L_pzb0
    s_sub_u32 s12, s12, 1
    s_cbranch_scc1 L_exit
    s_branch L_prb0
L_pzb0:
    s_mov_b64 exec, -1
L_pob0:
    ds_write_b128 v9, v[196:199] offset:0
    ds_write_b32 v12, v62 offset:0
    global_load_dwordx4 v[200:203], v229, s[60:61] sc1
    s_waitcnt vmcnt(0)
    v_max3_u32 v59, v200, v201, v202
    v_max_u32 v59, v59, v203
    v_cmp_eq_u32 vcc, -1, v59
    s_cbranch_vccz L_pob1
L_prb1:
    s_mov_b64 exec, vcc
    global_load_dwordx4 v[200:203], v229, s[60:61] sc1
    s_waitcnt vmcnt(0)
    v_max3_u32 v59, v200, v201, v202
    v_max_u32 v59, v59, v203
    v_cmp_eq_u32 vcc, -1, v59
    s_cbranch_vccz L_pzb1
    s_sub_u32 s12, s12, 1
    s_cbranch_scc1 L_exit
    s_branch L_prb1
L_pzb1:
    s_mov_b64 exec, -1
L_pob1:
    ds_write_b128 v9, v[200:203] offset:1024
    ds_write_b32 v12, v62 offset:8
    global_load_dwordx4 v[204:207], v230, s[60:61] sc1
    s_sleep 2
    global_load_dwordx4 v[208:211], v231, s[60:61] sc1
    s_waitcnt vmcnt(1)
    v_max3_u32 v59, v204, v205, v206
    v_max_u32 v59, v59, v207
    v_cmp_eq_u32 vcc, -1, v59
    s_cbranch_vccz L_pob2
L_prb2:
    s_mov_b64 exec, vcc
    global_load_dwordx4 v[204:207], v230, s[60:61] sc1
    s_waitcnt vmcnt(0)
    v_max3_u32 v59, v204, v205, v206
    v_max_u32 v59, v59, v207
    v_cmp_eq_u32 vcc, -1, v59
    s_cbranch_vccz L_pzb2
    s_sub_u32 s12, s12, 1
    s_cbranch_scc1 L_exit
    s_branch L_prb2
L_pzb2:
    s_mov_b64 exec, -1
L_pob2:
    ds_write_b128 v9, v[204:207] offset:2048
    ds_write_b32 v12, v62 offset:16
    s_waitcnt vmcnt(0)
    v_max3_u32 v59, v208, v209, v210
    v_max_u32 v59, v59, v211
    v_cmp_eq_u32 vcc, -1, v59
    s_cbranch_vccz L_pob3
L_prb3:
    s_mov_b64 exec, vcc
    global_load_dwordx4 v[208:211], v231, s[60:61] sc1
    s_waitcnt vmcnt(0)
    v_max3_u32 v59, v208, v209, v210
    v_max_u32 v59, v59, v211
    v_cmp_eq_u32 vcc, -1, v59
    s_cbranch_vccz L_pzb3
    s_sub_u32 s12, s12, 1
    s_cbranch_scc1 L_exit
    s_branch L_prb3
L_pzb3:
    s_mov_b64 exec, -1
L_pob3:
    ds_write_b128 v9, v[208:211] offset:3072
    ds_write_b32 v12, v62 offset:24
    s_branch L_post2
L_fin:
    s_cmp_eq_u32 s13, 1
    s_cbranch_scc0 L_cd2
L_cd2:
    s_cmp_eq_u32 s13, 2
    s_cbranch_scc0 L_nr2
    s_cmp_eq_u32 s13, 3
    s_cbranch_scc1 Lrc_27
    s_cmp_eq_u32 s13, 1
    s_mov_b32 s56, 4784128
    s_mov_b32 s58, 9568256
    s_cselect_b32 s56, s56, s58
    v_add_u32 v40, s56, v9
    global_store_dwordx4 v40, v[252:255], s[50:51] offset:0 sc1
    global_store_dwordx4 v40, v[252:255], s[50:51] offset:1024 sc1
    global_store_dwordx4 v40, v[252:255], s[50:51] offset:2048 sc1
    global_store_dwordx4 v40, v[252:255], s[50:51] offset:3072 sc1
Lrc_27:
    s_waitcnt vmcnt(0)
    s_mov_b64 exec, 1
    ds_add_u32 v15, v14 offset:80
    s_mov_b64 exec, -1
Ls_28:
    ds_read_b32 v41, v15 offset:80
    s_waitcnt lgkmcnt(0)
    v_cmp_le_u32 vcc, 2, v41
    s_cbranch_vccnz Lsd_29
    s_sleep 1
    s_sub_u32 s12, s12, 1
    s_cbranch_scc1 L_exit
    s_branch Ls_28
Lsd_29:
L_nr2:
Ls_30:
    ds_read_b32 v41, v15 offset:72
    s_waitcnt lgkmcnt(0)
    v_cmp_le_u32 vcc, s13, v41
    s_cbranch_vccnz Lsd_31
    s_sleep 2
    s_sub_u32 s12, s12, 1
    s_cbranch_scc1 L_exit
    s_branch Ls_30
Lsd_31:
    s_cmp_eq_u32 s13, 1
    s_cbranch_scc0 Lca_32
    v_add_u32 v40, 4784128, v8
    global_store_dwordx4 v40, v[252:255], s[50:51] offset:-3072 sc1
    global_store_dwordx4 v40, v[252:255], s[50:51] offset:-1024 sc1
    global_store_dwordx4 v40, v[252:255], s[50:51] offset:1024 sc1
    global_store_dwordx4 v40, v[252:255], s[50:51] offset:3072 sc1
Lca_32:
    s_cmp_eq_u32 s13, 1
    s_cbranch_scc0 Lra_33
    s_cmp_eq_u32 s13, 3
    s_cbranch_scc1 Lrc_34
    s_cmp_eq_u32 s13, 1
    s_mov_b32 s56, 4784128
    s_mov_b32 s58, 9568256
    s_cselect_b32 s56, s56, s58
    v_add_u32 v40, s56, v9
    global_store_dwordx4 v40, v[252:255], s[50:51] offset:0 sc1
    global_store_dwordx4 v40, v[252:255], s[50:51] offset:1024 sc1
    global_store_dwordx4 v40, v[252:255], s[50:51] offset:2048 sc1
    global_store_dwordx4 v40, v[252:255], s[50:51] offset:3072 sc1
Lrc_34:
Lra_33:
Lf_35:
    ds_read_b128 v[44:47], v11 offset:0
    ds_read_b128 v[64:67], v10 offset:0
    ds_read_b128 v[68:71], v10 offset:1024
    ds_read_b128 v[72:75], v10 offset:2048
    ds_read_b128 v[76:79], v10 offset:3072
    s_waitcnt lgkmcnt(4)
    v_min_u32 v44, v44, v45
    v_min3_u32 v44, v44, v46, v47
    v_cmp_eq_u32 vcc, v62, v44
    s_cbranch_vccnz Lfd_36
    s_sub_u32 s12, s12, 1
    s_cbranch_scc1 L_exit
    s_branch Lf_35
Lfd_36:
    s_waitcnt lgkmcnt(2)
    v_pk_add_f32 v[64:65], v[64:65], v[68:69]
    v_pk_add_f32 v[66:67], v[66:67], v[70:71]
    s_waitcnt lgkmcnt(0)
    v_pk_add_f32 v[72:73], v[72:73], v[76:77]
    v_pk_add_f32 v[74:75], v[74:75], v[78:79]
    v_cvt_pk_bf16_f32 v48, v64, v72
    v_cvt_pk_bf16_f32 v49, v65, v73
    v_cvt_pk_bf16_f32 v50, v66, v74
    v_cvt_pk_bf16_f32 v51, v67, v75
    v_min_u32 v48, -2, v48
    v_min_u32 v49, -2, v49
    v_min_u32 v50, -2, v50
    v_min_u32 v51, -2, v51
    global_store_dwordx4 v8, v[48:51], s[52:53] offset:-3072 sc1
    ds_write_b32 v12, v62 offset:0
    s_cmp_eq_u32 s13, 2
    s_cbranch_scc0 Lca_37
    v_add_u32 v40, 9568256, v8
    global_store_dwordx4 v40, v[252:255], s[50:51] offset:-3072 sc1
    global_store_dwordx4 v40, v[252:255], s[50:51] offset:-1024 sc1
    global_store_dwordx4 v40, v[252:255], s[50:51] offset:1024 sc1
    global_store_dwordx4 v40, v[252:255], s[50:51] offset:3072 sc1
Lca_37:
Lf_38:
    ds_read_b128 v[44:47], v11 offset:32
    ds_read_b128 v[64:67], v10 offset:8192
    ds_read_b128 v[68:71], v10 offset:9216
    ds_read_b128 v[72:75], v10 offset:10240
    ds_read_b128 v[76:79], v10 offset:11264
    s_waitcnt lgkmcnt(4)
    v_min_u32 v44, v44, v45
    v_min3_u32 v44, v44, v46, v47
    v_cmp_eq_u32 vcc, v62, v44
    s_cbranch_vccnz Lfd_39
    s_sub_u32 s12, s12, 1
    s_cbranch_scc1 L_exit
    s_branch Lf_38
Lfd_39:
    s_waitcnt lgkmcnt(2)
    v_pk_add_f32 v[64:65], v[64:65], v[68:69]
    v_pk_add_f32 v[66:67], v[66:67], v[70:71]
    s_waitcnt lgkmcnt(0)
    v_pk_add_f32 v[72:73], v[72:73], v[76:77]
    v_pk_add_f32 v[74:75], v[74:75], v[78:79]
    v_cvt_pk_bf16_f32 v48, v64, v72
    v_cvt_pk_bf16_f32 v49, v65, v73
    v_cvt_pk_bf16_f32 v50, v66, v74
    v_cvt_pk_bf16_f32 v51, v67, v75
    v_min_u32 v48, -2, v48
    v_min_u32 v49, -2, v49
    v_min_u32 v50, -2, v50
    v_min_u32 v51, -2, v51
    global_store_dwordx4 v8, v[48:51], s[52:53] offset:-1024 sc1
    ds_write_b32 v12, v62 offset:8
Lf_40:
    ds_read_b128 v[44:47], v11 offset:64
    ds_read_b128 v[64:67], v10 offset:16384
    ds_read_b128 v[68:71], v10 offset:17408
    ds_read_b128 v[72:75], v10 offset:18432
    ds_read_b128 v[76:79], v10 offset:19456
    s_waitcnt lgkmcnt(4)
    v_min_u32 v44, v44, v45
    v_min3_u32 v44, v44, v46, v47
    v_cmp_eq_u32 vcc, v62, v44
    s_cbranch_vccnz Lfd_41
    s_sub_u32 s12, s12, 1
    s_cbranch_scc1 L_exit
    s_branch Lf_40
Lfd_41:
    s_waitcnt lgkmcnt(2)
    v_pk_add_f32 v[64:65], v[64:65], v[68:69]
    v_pk_add_f32 v[66:67], v[66:67], v[70:71]
    s_waitcnt lgkmcnt(0)
    v_pk_add_f32 v[72:73], v[72:73], v[76:77]
    v_pk_add_f32 v[74:75], v[74:75], v[78:79]
    v_cvt_pk_bf16_f32 v48, v64, v72
    v_cvt_pk_bf16_f32 v49, v65, v73
    v_cvt_pk_bf16_f32 v50, v66, v74
    v_cvt_pk_bf16_f32 v51, v67, v75
    v_min_u32 v48, -2, v48
    v_min_u32 v49, -2, v49
    v_min_u32 v50, -2, v50
    v_min_u32 v51, -2, v51
    global_store_dwordx4 v8, v[48:51], s[52:53] offset:1024 sc1
    ds_write_b32 v12, v62 offset:16
Lf_42:
    ds_read_b128 v[44:47], v11 offset:96
    ds_read_b128 v[64:67], v10 offset:24576
    ds_read_b128 v[68:71], v10 offset:25600
    ds_read_b128 v[72:75], v10 offset:26624
    ds_read_b128 v[76:79], v10 offset:27648
    s_waitcnt lgkmcnt(4)
    v_min_u32 v44, v44, v45
    v_min3_u32 v44, v44, v46, v47
    v_cmp_eq_u32 vcc, v62, v44
    s_cbranch_vccnz Lfd_43
    s_sub_u32 s12, s12, 1
    s_cbranch_scc1 L_exit
    s_branch Lf_42
Lfd_43:
    s_waitcnt lgkmcnt(2)
    v_pk_add_f32 v[64:65], v[64:65], v[68:69]
    v_pk_add_f32 v[66:67], v[66:67], v[70:71]
    s_waitcnt lgkmcnt(0)
    v_pk_add_f32 v[72:73], v[72:73], v[76:77]
    v_pk_add_f32 v[74:75], v[74:75], v[78:79]
    v_cvt_pk_bf16_f32 v48, v64, v72
    v_cvt_pk_bf16_f32 v49, v65, v73
    v_cvt_pk_bf16_f32 v50, v66, v74
    v_cvt_pk_bf16_f32 v51, v67, v75
    v_min_u32 v48, -2, v48
    v_min_u32 v49, -2, v49
    v_min_u32 v50, -2, v50
    v_min_u32 v51, -2, v51
    global_store_dwordx4 v8, v[48:51], s[52:53] offset:3072 sc1
    ds_write_b32 v12, v62 offset:24
    s_cmp_eq_u32 s13, 1
    s_cbranch_scc0 L_post2
    s_waitcnt vmcnt(4)
    s_mov_b64 exec, 1
    ds_add_rtn_u32 v41, v15, v14 offset:84
    s_waitcnt lgkmcnt(0)
    v_and_b32 v41, 1, v41
    v_cmp_eq_u32 vcc, 1, v41
    s_cbranch_vccz Lpb_44
    s_lshl_b32 s56, s13, 14
    s_lshr_b32 s58, s2, 2
    s_lshl_b32 s58, s58, 7
    s_add_u32 s56, s56, s58
    s_and_b32 s58, s2, 3
    s_lshl_b32 s58, s58, 2
    s_add_u32 s56, s56, s58
    s_add_u32 s56, s56, 14344192
    v_mov_b32 v41, s56
    v_mov_b32 v42, s54
    global_store_dword v41, v42, s[50:51] sc1
Lpb_44:
    s_mov_b64 exec, -1
    s_branch L_hk3
L_row:
    s_add_u32 s52, s52, 4784128
    s_addc_u32 s53, s53, 0
    s_cmp_eq_u32 s13, 1
    s_mov_b32 s56, 4784128
    s_mov_b32 s58, 9568256
    s_cselect_b32 s56, s56, s58
    s_add_u32 s60, s50, s56
    s_addc_u32 s61, s51, 0
    s_add_u32 s54, s54, 2
    v_mov_b32 v72, 0x3b000000
    v_mov_b32 v73, 0x3727c5ac
    s_lshr_b32 s56, s3, 1
    s_cmp_eq_u32 s56, 2
    s_cselect_b32 s57, s11, 0
    s_cmp_eq_u32 s13, 2
    s_cbranch_scc1 L_R2
    s_cmp_eq_u32 s13, 3
    s_cbranch_scc1 L_R3
    s_waitcnt lgkmcnt(0)
    s_barrier
    ds_read_b128 v[24:27], v5
    s_cmp_eq_u32 s56, 2
    s_cbranch_scc0 L_ntb
    s_lshl_b32 s56, s13, 14
    s_add_u32 s56, s56, 14344192
    v_lshl_add_u32 v236, v1, 7, s56
    global_load_dwordx4 v[192:195], v236, s[50:51] sc1
L_ntb:
    s_waitcnt lgkmcnt(0)
    v_lshlrev_b32 v40, 16, v24
    v_and_b32 v41, 0xffff0000, v24
    v_lshlrev_b32 v42, 16, v25
    v_and_b32 v43, 0xffff0000, v25
    v_lshlrev_b32 v44, 16, v26
    v_and_b32 v45, 0xffff0000, v26
    v_lshlrev_b32 v46, 16, v27
    v_and_b32 v47, 0xffff0000, v27
    v_pk_fma_f32 v[16:17], v[32:33], v[40:41], v[16:17]
    v_pk_fma_f32 v[18:19], v[34:35], v[42:43], v[18:19]
    v_pk_fma_f32 v[20:21], v[36:37], v[44:45], v[20:21]
    v_pk_fma_f32 v[22:23], v[38:39], v[46:47], v[22:23]
    s_branch L_ln2
L_R3:
    v_lshl_add_u32 v41, v1, 4, s6
    s_waitcnt lgkmcnt(0)
    s_barrier
    ds_read_b128 v[48:51], v5
    s_waitcnt lgkmcnt(0)
    v_lshlrev_b32 v76, 16, v48
    v_and_b32 v77, 0xffff0000, v48
    v_lshlrev_b32 v78, 16, v49
    v_and_b32 v79, 0xffff0000, v49
    v_lshlrev_b32 v80, 16, v50
    v_and_b32 v81, 0xffff0000, v50
    v_lshlrev_b32 v82, 16, v51
    v_and_b32 v83, 0xffff0000, v51
    v_pk_add_f32 v[16:17], v[16:17], v[76:77]
    v_pk_add_f32 v[18:19], v[18:19], v[78:79]
    v_pk_add_f32 v[20:21], v[20:21], v[80:81]
    v_pk_add_f32 v[22:23], v[22:23], v[82:83]
    s_branch L_out
L_R2:
    v_lshlrev_b32 v40, 16, v24
    v_and_b32 v41, 0xffff0000, v24
    v_lshlrev_b32 v42, 16, v25
    v_and_b32 v43, 0xffff0000, v25
    v_lshlrev_b32 v44, 16, v26
    v_and_b32 v45, 0xffff0000, v26
    v_lshlrev_b32 v46, 16, v27
    v_and_b32 v47, 0xffff0000, v27
    s_waitcnt lgkmcnt(0)
    s_barrier
    ds_read_b128 v[48:51], v5
    s_cmp_eq_u32 s57, 1
    s_cbranch_scc0 L_ge1
    global_load_dwordx4 v[196:199], v228, s[60:61] sc1
L_ge1:
    s_waitcnt lgkmcnt(0)
    v_lshlrev_b32 v76, 16, v48
    v_and_b32 v77, 0xffff0000, v48
    v_lshlrev_b32 v78, 16, v49
    v_and_b32 v79, 0xffff0000, v49
    v_lshlrev_b32 v80, 16, v50
    v_and_b32 v81, 0xffff0000, v50
    v_lshlrev_b32 v82, 16, v51
    v_and_b32 v83, 0xffff0000, v51
    v_pk_add_f32 v[16:17], v[16:17], v[76:77]
    v_pk_add_f32 v[18:19], v[18:19], v[78:79]
    v_pk_add_f32 v[20:21], v[20:21], v[80:81]
    v_pk_add_f32 v[22:23], v[22:23], v[82:83]
    v_pk_add_f32 v[64:65], v[16:17], v[18:19]
    v_pk_mul_f32 v[68:69], v[16:17], v[16:17]
    v_pk_add_f32 v[66:67], v[20:21], v[22:23]
    v_pk_mul_f32 v[70:71], v[20:21], v[20:21]
    v_pk_fma_f32 v[68:69], v[18:19], v[18:19], v[68:69]
    v_pk_fma_f32 v[70:71], v[22:23], v[22:23], v[70:71]
    v_pk_add_f32 v[64:65], v[64:65], v[66:67]
    v_pk_add_f32 v[68:69], v[68:69], v[70:71]
    v_add_f32 v64, v64, v65
    v_add_f32 v68, v68, v69
    s_nop 1
    v_permlane32_swap_b32 v64, v68
    v_add_f32 v64, v64, v68
    s_nop 1
    v_add_f32_dpp v64, v64, v64 row_ror:8 row_mask:0xf bank_mask:0xf
    s_nop 1
    v_add_f32_dpp v64, v64, v64 row_ror:4 row_mask:0xf bank_mask:0xf
    s_nop 1
    v_add_f32_dpp v64, v64, v64 row_ror:2 row_mask:0xf bank_mask:0xf
    s_nop 1
    v_add_f32_dpp v64, v64, v64 row_ror:1 row_mask:0xf bank_mask:0xf
    s_nop 1
    v_add_f32_dpp v64, v64, v64 row_bcast:15 row_mask:0xa bank_mask:0xf
    s_nop 0
    v_readlane_b32 s62, v64, 31
    v_readlane_b32 s63, v64, 63
    s_nop 0
    v_mul_f32 v64, s62, v72
    v_fma_f32 v66, s63, v72, v73
    v_fma_f32 v66, -v64, v64, v66
    v_max_f32 v66, v73, v66
    v_rsq_f32 v66, v66
    s_nop 0
    v_mul_f32_e64 v64, v64, -v66
    v_pk_fma_f32 v[32:33], v[16:17], v[66:67], v[64:65] op_sel_hi:[1,0,0]
    v_pk_fma_f32 v[34:35], v[18:19], v[66:67], v[64:65] op_sel_hi:[1,0,0]
    v_pk_fma_f32 v[36:37], v[20:21], v[66:67], v[64:65] op_sel_hi:[1,0,0]
    v_pk_fma_f32 v[38:39], v[22:23], v[66:67], v[64:65] op_sel_hi:[1,0,0]
    v_pk_fma_f32 v[16:17], v[32:33], v[40:41], v[16:17]
    v_pk_fma_f32 v[18:19], v[34:35], v[42:43], v[18:19]
    v_pk_fma_f32 v[20:21], v[36:37], v[44:45], v[20:21]
    v_pk_fma_f32 v[22:23], v[38:39], v[46:47], v[22:23]
    s_cmp_eq_u32 s57, 2
    s_cbranch_scc0 L_ge2
    global_load_dwordx4 v[196:199], v228, s[60:61] sc1
L_ge2:
L_ln2:
    v_pk_add_f32 v[64:65], v[16:17], v[18:19]
    v_pk_mul_f32 v[68:69], v[16:17], v[16:17]
    v_pk_add_f32 v[66:67], v[20:21], v[22:23]
    v_pk_mul_f32 v[70:71], v[20:21], v[20:21]
    v_pk_fma_f32 v[68:69], v[18:19], v[18:19], v[68:69]
    v_pk_fma_f32 v[70:71], v[22:23], v[22:23], v[70:71]
    v_pk_add_f32 v[64:65], v[64:65], v[66:67]
    v_pk_add_f32 v[68:69], v[68:69], v[70:71]
    v_add_f32 v64, v64, v65
    v_add_f32 v68, v68, v69
    s_nop 1
    v_permlane32_swap_b32 v64, v68
    v_add_f32 v64, v64, v68
    s_nop 1
    v_add_f32_dpp v64, v64, v64 row_ror:8 row_mask:0xf bank_mask:0xf
    s_nop 1
    v_add_f32_dpp v64, v64, v64 row_ror:4 row_mask:0xf bank_mask:0xf
    s_nop 1
    v_add_f32_dpp v64, v64, v64 row_ror:2 row_mask:0xf bank_mask:0xf
    s_nop 1
    v_add_f32_dpp v64, v64, v64 row_ror:1 row_mask:0xf bank_mask:0xf
    s_nop 1
    v_add_f32_dpp v64, v64, v64 row_bcast:15 row_mask:0xa bank_mask:0xf
    s_nop 0
    v_readlane_b32 s62, v64, 31
    v_readlane_b32 s63, v64, 63
    s_nop 0
    v_mul_f32 v64, s62, v72
    v_fma_f32 v66, s63, v72, v73
    v_fma_f32 v66, -v64, v64, v66
    v_max_f32 v66, v73, v66
    v_rsq_f32 v66, v66
    s_nop 0
    v_mul_f32_e64 v64, v64, -v66
    v_pk_fma_f32 v[32:33], v[16:17], v[66:67], v[64:65] op_sel_hi:[1,0,0]
    v_pk_fma_f32 v[34:35], v[18:19], v[66:67], v[64:65] op_sel_hi:[1,0,0]
    v_pk_fma_f32 v[36:37], v[20:21], v[66:67], v[64:65] op_sel_hi:[1,0,0]
    v_pk_fma_f32 v[38:39], v[22:23], v[66:67], v[64:65] op_sel_hi:[1,0,0]
    s_cmp_ge_u32 s3, 6
    s_cbranch_scc0 L_nak
    s_waitcnt vmcnt(0)
L_nak:
    v_cvt_pk_bf16_f32 v40, v32, v33
    v_cvt_pk_bf16_f32 v41, v34, v35
    v_cvt_pk_bf16_f32 v42, v36, v37
    v_cvt_pk_bf16_f32 v43, v38, v39
    ds_write_b128 v6, v[40:43]
    s_lshr_b32 s56, s3, 1
    s_waitcnt lgkmcnt(0)
    s_barrier
    s_cmp_eq_u32 s56, 2
    s_cbranch_scc1 Lss_45
    ds_read_b64_tr_b16 v[44:45], v7 offset:4608
    ds_read_b64_tr_b16 v[46:47], v7 offset:256
    s_cmp_eq_u32 s56, 3
    s_cbranch_scc0 Lso_46
    ds_read_b64_tr_b16 v[48:49], v7 offset:4352
    ds_read_b64_tr_b16 v[50:51], v7
    s_waitcnt lgkmcnt(0)
    v_min_u32 v48, -2, v48
    v_min_u32 v49, -2, v49
    v_min_u32 v50, -2, v50
    v_min_u32 v51, -2, v51
    global_store_dwordx4 v3, v[48:51], s[60:61] offset:-2048 sc1
Lso_46:
    s_waitcnt lgkmcnt(0)
    v_min_u32 v44, -2, v44
    v_min_u32 v45, -2, v45
    v_min_u32 v46, -2, v46
    v_min_u32 v47, -2, v47
    global_store_dwordx4 v3, v[44:47], s[60:61] sc1
Lss_45:
    s_add_u32 s13, s13, 1
    s_cmp_eq_u32 s13, 3
    s_cselect_b32 s68, s8, s9
    s_cbranch_scc1 L_loop
    s_cmp_lt_u32 s3, 4
    s_cbranch_scc0 L_loop
    ds_read_b64 v[128:129], v10 offset:0
    ds_read_b64 v[130:131], v10 offset:8
    ds_read_b64 v[160:161], v10 offset:64
    ds_read_b64 v[162:163], v10 offset:72
    ds_read_b64 v[192:193], v10 offset:128
    ds_read_b64 v[194:195], v10 offset:136
    ds_read_b64 v[224:225], v10 offset:192
    ds_read_b64 v[226:227], v10 offset:200
    ds_read_b64 v[132:133], v10 offset:512
    ds_read_b64 v[134:135], v10 offset:520
    ds_read_b64 v[164:165], v10 offset:576
    ds_read_b64 v[166:167], v10 offset:584
    ds_read_b64 v[196:197], v10 offset:640
    ds_read_b64 v[198:199], v10 offset:648
    ds_read_b64 v[228:229], v10 offset:704
    ds_read_b64 v[230:231], v10 offset:712
    ds_read_b64 v[136:137], v10 offset:1024
    ds_read_b64 v[138:139], v10 offset:1032
    ds_read_b64 v[168:169], v10 offset:1088
    ds_read_b64 v[170:171], v10 offset:1096
    ds_read_b64 v[200:201], v10 offset:1152
    ds_read_b64 v[202:203], v10 offset:1160
    ds_read_b64 v[232:233], v10 offset:1216
    ds_read_b64 v[234:235], v10 offset:1224
    ds_read_b64 v[140:141], v10 offset:1536
    ds_read_b64 v[142:143], v10 offset:1544
    ds_read_b64 v[172:173], v10 offset:1600
    ds_read_b64 v[174:175], v10 offset:1608
    ds_read_b64 v[204:205], v10 offset:1664
    ds_read_b64 v[206:207], v10 offset:1672
    ds_read_b64 v[236:237], v10 offset:1728
    ds_read_b64 v[238:239], v10 offset:1736
    ds_read_b64 v[144:145], v10 offset:2048
    ds_read_b64 v[146:147], v10 offset:2056
    ds_read_b64 v[176:177], v10 offset:2112
    ds_read_b64 v[178:179], v10 offset:2120
    ds_read_b64 v[208:209], v10 offset:2176
    ds_read_b64 v[210:211], v10 offset:2184
    ds_read_b64 v[240:241], v10 offset:2240
    ds_read_b64 v[242:243], v10 offset:2248
    ds_read_b64 v[148:149], v10 offset:2560
    ds_read_b64 v[150:151], v10 offset:2568
    ds_read_b64 v[180:181], v10 offset:2624
    ds_read_b64 v[182:183], v10 offset:2632
    ds_read_b64 v[212:213], v10 offset:2688
    ds_read_b64 v[214:215], v10 offset:2696
    ds_read_b64 v[244:245], v10 offset:2752
    ds_read_b64 v[246:247], v10 offset:2760
    ds_read_b64 v[152:153], v10 offset:3072
    ds_read_b64 v[154:155], v10 offset:3080
    ds_read_b64 v[184:185], v10 offset:3136
    ds_read_b64 v[186:187], v10 offset:3144
    ds_read_b64 v[216:217], v10 offset:3200
    ds_read_b64 v[218:219], v10 offset:3208
    ds_read_b64 v[248:249], v10 offset:3264
    ds_read_b64 v[250:251], v10 offset:3272
    ds_read_b64 v[156:157], v10 offset:3584
    ds_read_b64 v[158:159], v10 offset:3592
    ds_read_b64 v[188:189], v10 offset:3648
    ds_read_b64 v[190:191], v10 offset:3656
    ds_read_b64 v[220:221], v10 offset:3712
    ds_read_b64 v[222:223], v10 offset:3720
    ds_read_b64 v[252:253], v10 offset:3776
    ds_read_b64 v[254:255], v10 offset:3784
    s_branch L_loop
L_out:
    v_cvt_pk_bf16_f32 v44, v16, v17
    v_cvt_pk_bf16_f32 v45, v18, v19
    v_cvt_pk_bf16_f32 v46, v20, v21
    v_cvt_pk_bf16_f32 v47, v22, v23
    global_store_dwordx4 v41, v[44:47], s[46:47]
    s_cmp_eq_u32 s6, 0
    s_cbranch_scc0 L_nogen
    s_add_u32 s56, s54, 1
    v_mov_b32 v41, 50331648
    v_mov_b32 v42, s56
    global_store_dword v41, v42, s[50:51]
L_nogen:
L_exit:
    s_endpgm
.fill 2048, 4, 0xbf800000
.section .rodata,"a"
.p2align 6
.amdhsa_kernel interleave_layers__ssm_conv_h3__ssm_conv_s4__prompt_kernel
  .amdhsa_next_free_vgpr 256
  .amdhsa_next_free_sgpr 102
  .amdhsa_accum_offset 256
  .amdhsa_group_segment_fixed_size 0
  .amdhsa_kernarg_size 144
  .amdhsa_user_sgpr_count 2
  .amdhsa_user_sgpr_kernarg_segment_ptr 1
  .amdhsa_system_sgpr_workgroup_id_x 1
.end_amdhsa_kernel
```
